```python
import torch

def _softmax(x, axis=-1):
    return torch.softmax(x, dim=axis)
def _gelu(x):
    return torch.nn.functional.gelu(x, approximate="tanh")
def _silu(x):
    return torch.nn.functional.silu(x)
def _sigmoid(x):
    return torch.sigmoid(x)
def _layernorm(x, axis=-1, eps=1e-5):
    m = x.mean(dim=axis, keepdim=True)
    v = x.var(dim=axis, keepdim=True, unbiased=False)
    return (x - m) / torch.sqrt(v + eps)
def _scatter_add(tgt, idx, src, axis=0):
    return tgt.clone().index_add_(axis, idx, src)
def _segment_sum(src, seg, n):
    out = torch.zeros((n,) + src.shape[1:], dtype=src.dtype)
    return out.index_add_(0, seg, src)
def _pad(x, pw):
    flat = tuple(v for pair in reversed(pw) for v in pair)
    return torch.nn.functional.pad(x, flat)

kernel_name = 'concat_heads__grouped_kv_mqa__linear_kernel_hedgehog__prompt'

def setup_inputs():

    _w = (lambda a: (lambda t: t.to(torch.bfloat16) if t.is_floating_point() else t)(torch.as_tensor(a)))
    def _A_setup():
        B, S, D, H = 1, 2048, 640, 32
        Dh = D // H
        return {
            "x": _w((lambda *s: torch.randn(*s, dtype=torch.bfloat16) * 0.05)(B, S, D)),
            "wq": _w((lambda *s: torch.randn(*s, dtype=torch.bfloat16) * 1.6)(D, H * Dh)),
            "wk": _w((lambda *s: torch.randn(*s, dtype=torch.bfloat16) * 1.6)(D, Dh)),
            "wv": _w((lambda *s: torch.randn(*s, dtype=torch.bfloat16) * 0.1)(D, Dh)),
            "wo": _w((lambda *s: torch.randn(*s, dtype=torch.bfloat16) * 0.1)(H * Dh, D)),
        }
    _A_in = _A_setup()

    def _B_setup():
        B, S, D, H = 1, 2048, 640, 32
        Dh = D // H
        return {
            "x": _w((lambda *s: torch.randn(*s, dtype=torch.bfloat16) * 0.4)(B, S, D)),
            "wqkv": _w((lambda *s: torch.randn(*s, dtype=torch.bfloat16) * 0.4)(D, 3 * D)),
            "w_phi": _w((lambda *s: torch.randn(*s, dtype=torch.bfloat16) * 0.4)(H, Dh, Dh) * (Dh ** -0.5)),
            "wo": _w((lambda *s: torch.randn(*s, dtype=torch.bfloat16) * 0.05)(D, D)),
        }
    _B_in = _B_setup()

    return {
        "A_x": _A_in["x"],
        "A_wq": _A_in["wq"],
        "A_wk": _A_in["wk"],
        "A_wv": _A_in["wv"],
        "A_wo": _A_in["wo"],
        "B_x": _B_in["x"],
        "B_wqkv": _B_in["wqkv"],
        "B_w_phi": _B_in["w_phi"],
        "B_wo": _B_in["wo"],
    }

def reference(A_x, A_wq, A_wk, A_wv, A_wo, B_x, B_wqkv, B_w_phi, B_wo):
    def _A_ref(x, wq, wk, wv, wo):
        B, S, D = x.shape
        H = 32
        Dh = D // H
        q = (lambda x, *d: x.permute(*d))((x @ wq).reshape(B, S, H, Dh), 0, 2, 1, 3)
        k = x @ wk
        v = x @ wv
        scores = torch.einsum("bhqd,bkd->bhqk", q, k) * (Dh ** -0.5)
        p = _softmax(scores, axis=-1)
        o = torch.einsum("bhqk,bkd->bhqd", p, v)
        return (lambda x, *d: x.permute(*d))(o, 0, 2, 1, 3).reshape(B, S, H * Dh) @ wo

    def _B_ref(x, wqkv, w_phi, wo):
        B, S, D = x.shape
        H = 32; Dh = D // H
        qkv = (lambda x, *d: x.permute(*d))((x @ wqkv).reshape(B, S, 3, H, Dh), 2, 0, 3, 1, 4)
        q, k, v = qkv[0], qkv[1], qkv[2]
        pq = torch.einsum("bhsd,hdf->bhsf", q, w_phi)
        pk = torch.einsum("bhsd,hdf->bhsf", k, w_phi)
        phi_q = torch.concatenate([_softmax(pq, axis=-1), _softmax(-pq, axis=-1)], axis=-1)
        phi_k = torch.concatenate([_softmax(pk, axis=-1), _softmax(-pk, axis=-1)], axis=-1)
        kv = torch.einsum("bhsf,bhsd->bhfd", phi_k, v)
        z  = torch.einsum("bhsf->bhf", phi_k)
        num = torch.einsum("bhqf,bhfd->bhqd", phi_q, kv)
        den = torch.einsum("bhqf,bhf->bhq", phi_q, z)[..., None] + 1e-6
        o = num / den
        return (lambda x, *d: x.permute(*d))(o, 0, 2, 1, 3).reshape(B, S, D) @ wo

    a = _A_ref(A_x, A_wq, A_wk, A_wv, A_wo)
    b = _B_ref(B_x, B_wqkv, B_w_phi, B_wo)
    return torch.concatenate([a, b], axis=-1)
```

```asm
; @launch grid=(256,1,1) block=(512,1,1) lds=159744
.amdgcn_target "amdgcn-amd-amdhsa--gfx950"
.text
.globl concat_heads__grouped_kv_mqa__linear_kernel_hedgehog__prompt_kernel
.p2align 8
.type concat_heads__grouped_kv_mqa__linear_kernel_hedgehog__prompt_kernel,@function
concat_heads__grouped_kv_mqa__linear_kernel_hedgehog__prompt_kernel:
  s_cmp_ge_u32 s2, 256
  s_cbranch_scc1 concat_heads__grouped_kv_mqa__linear_kernel_hedgehog__prompt_kernel_end
  s_load_dwordx4 s[32:35], s[0:1], 0
  s_load_dwordx4 s[36:39], s[0:1], 40
  s_load_dwordx4 s[84:87], s[0:1], 16
  s_load_dwordx2 s[88:89], s[0:1], 56
  s_load_dwordx2 s[4:5], s[0:1], 88
  s_load_dwordx2 s[6:7], s[0:1], 80
  s_load_dwordx2 s[90:91], s[0:1], 72
  s_load_dwordx2 s[92:93], s[0:1], 32
  s_load_dwordx2 s[94:95], s[0:1], 64
  v_lshrrev_b32 v2, 6, v0
  v_and_b32 v1, 63, v0
  s_and_b32 s40, s2, 3
  s_lshr_b32 s41, s2, 2
  s_and_b32 s41, s41, 1
  s_lshr_b32 s42, s2, 3
  s_and_b32 s43, s42, 7
  s_lshl_b32 s41, s41, 3
  s_add_u32 s41, s41, s43
  s_lshr_b32 s42, s42, 3
  s_mul_i32 s45, s42, 3
  s_add_u32 s43, s43, s45
  s_cmp_ge_u32 s43, 10
  s_cselect_b32 s45, 10, 0
  s_sub_u32 s43, s43, s45
  s_cmp_eq_u32 s40, 0
  s_movk_i32 s44, 3840
  s_cselect_b32 s44, 1280, s44
  v_readfirstlane_b32 s100, v2
  s_nop 3
  s_cmp_lt_u32 s100, 4
  s_cbranch_scc1 concat_heads__grouped_kv_mqa__linear_kernel_hedgehog__prompt_kernel_compute
  s_sub_u32 s3, s100, 4
  v_lshrrev_b32 v32, 3, v1
  v_and_b32 v33, 7, v1
  v_xor_b32 v33, v33, v32
  v_lshlrev_b32 v33, 4, v33
  v_mul_u32_u24 v32, 1280, v32
  v_add_u32 v16, v32, v33
  v_add_u32 v17, 10240, v16
  v_add_u32 v18, 20480, v16
  v_add_u32 v19, 30720, v16
  v_add_u32 v32, 0, v1
  v_mul_u32_u24 v33, 6554, v32
  v_lshrrev_b32 v33, 16, v33
  v_mul_u32_u24 v34, 10, v33
  v_sub_u32 v34, v32, v34
  v_and_b32 v35, 0x33, v33
  v_and_b32 v36, 4, v33
  v_lshlrev_b32 v36, 1, v36
  v_and_b32 v37, 8, v33
  v_lshrrev_b32 v37, 1, v37
  v_or3_b32 v35, v35, v36, v37
  v_mul_lo_u32 v35, v35, s44
  v_lshl_add_u32 v24, v34, 4, v35
  v_add_u32 v32, 64, v1
  v_mul_u32_u24 v33, 6554, v32
  v_lshrrev_b32 v33, 16, v33
  v_mul_u32_u24 v34, 10, v33
  v_sub_u32 v34, v32, v34
  v_and_b32 v35, 0x33, v33
  v_and_b32 v36, 4, v33
  v_lshlrev_b32 v36, 1, v36
  v_and_b32 v37, 8, v33
  v_lshrrev_b32 v37, 1, v37
  v_or3_b32 v35, v35, v36, v37
  v_mul_lo_u32 v35, v35, s44
  v_lshl_add_u32 v25, v34, 4, v35
  v_add_u32 v32, 128, v1
  v_mul_u32_u24 v33, 6554, v32
  v_lshrrev_b32 v33, 16, v33
  v_mul_u32_u24 v34, 10, v33
  v_sub_u32 v34, v32, v34
  v_and_b32 v35, 0x33, v33
  v_and_b32 v36, 4, v33
  v_lshlrev_b32 v36, 1, v36
  v_and_b32 v37, 8, v33
  v_lshrrev_b32 v37, 1, v37
  v_or3_b32 v35, v35, v36, v37
  v_mul_lo_u32 v35, v35, s44
  v_lshl_add_u32 v26, v34, 4, v35
  v_add_u32 v32, 192, v1
  v_mul_u32_u24 v33, 6554, v32
  v_lshrrev_b32 v33, 16, v33
  v_mul_u32_u24 v34, 10, v33
  v_sub_u32 v34, v32, v34
  v_and_b32 v35, 0x33, v33
  v_and_b32 v36, 4, v33
  v_lshlrev_b32 v36, 1, v36
  v_and_b32 v37, 8, v33
  v_lshrrev_b32 v37, 1, v37
  v_or3_b32 v35, v35, v36, v37
  v_mul_lo_u32 v35, v35, s44
  v_lshl_add_u32 v27, v34, 4, v35
  v_add_u32 v32, 256, v1
  v_mul_u32_u24 v33, 6554, v32
  v_lshrrev_b32 v33, 16, v33
  v_mul_u32_u24 v34, 10, v33
  v_sub_u32 v34, v32, v34
  v_and_b32 v35, 0x33, v33
  v_and_b32 v36, 4, v33
  v_lshlrev_b32 v36, 1, v36
  v_and_b32 v37, 8, v33
  v_lshrrev_b32 v37, 1, v37
  v_or3_b32 v35, v35, v36, v37
  v_mul_lo_u32 v35, v35, s44
  v_lshl_add_u32 v28, v34, 4, v35
  v_lshlrev_b32 v40, 4, v1
  s_lshr_b32 s45, s3, 1
  s_mul_i32 s46, s42, 160
  s_mul_i32 s47, s45, 80
  s_add_u32 s46, s46, s47
  s_sub_u32 s47, s40, 2
  s_lshl_b32 s47, s47, 2
  s_add_u32 s47, s47, s42
  s_mov_b32 s59, s47
  s_mul_i32 s47, s47, 80
  s_mul_i32 s48, s45, 640
  s_add_u32 s47, s47, s48
  s_add_u32 s47, s47, 640
  s_cmp_ge_u32 s40, 2
  s_cselect_b32 s46, s47, s46
  s_lshl_b32 s20, s41, 7
  s_lshl_b32 s49, s3, 5
  s_add_u32 s20, s20, s49
  s_mul_i32 s20, s20, 1280
  s_and_b32 s49, s3, 1
  s_lshl_b32 s49, s49, 5
  s_mul_i32 s21, s49, s44
  s_lshl_b32 s49, s46, 1
  s_add_u32 s21, s21, s49
  s_lshl_b32 s22, s44, 6
  s_lshl_b32 s24, s3, 12
  s_lshr_b32 s49, s3, 1
  s_mul_i32 s25, s49, 10240
  s_and_b32 s49, s3, 1
  s_mul_i32 s49, s49, 5120
  s_add_u32 s25, s25, s49
  s_add_u32 s25, s25, 16384
  s_mov_b32 s23, s43
  s_mul_i32 s57, s42, 6400
  s_mul_i32 s58, s59, 3200
  s_cmp_ge_u32 s40, 2
  s_cselect_b32 s57, s58, s57
  s_lshl_b32 s58, s3, 11
  s_add_u32 s57, s57, s58
  s_add_u32 s58, s58, 147456
  s_waitcnt lgkmcnt(0)
  s_cmp_eq_u32 s40, 0
  s_cselect_b32 s8, s32, s36
  s_cselect_b32 s9, s33, s37
  s_cselect_b32 s12, s34, s38
  s_cselect_b32 s13, s35, s39
  s_mov_b32 s14, 2457600
  s_cselect_b32 s14, 819200, s14
  s_and_b32 s9, s9, 0xffff
  s_mov_b32 s10, 2621440
  s_mov_b32 s11, 0x20000
  s_and_b32 s13, s13, 0xffff
  s_mov_b32 s15, 0x20000
  s_mov_b32 s16, s88
  s_and_b32 s17, s89, 0xffff
  s_mov_b32 s18, 25600
  s_mov_b32 s19, 0x00020000
  s_mov_b32 m0, s58
  s_nop 0
  buffer_load_dwordx4 v40, s[16:19], s57 offen lds
  buffer_load_dwordx4 v40, s[16:19], s57 offen offset:1024 lds
  s_or_b32 s57, s40, s3
  s_cmp_lg_u32 s57, 0
  s_cbranch_scc1 concat_heads__grouped_kv_mqa__linear_kernel_hedgehog__prompt_kernel_nwt
  s_mov_b32 s48, s84
  s_and_b32 s49, s85, 0xffff
  s_mov_b32 s50, 25600
  s_mov_b32 s51, 0x00020000
  s_mov_b32 s52, s86
  s_and_b32 s53, s87, 0xffff
  s_mov_b32 s54, 25600
  s_mov_b32 s55, 0x00020000
  s_lshr_b32 s57, s2, 3
  s_and_b32 s57, s57, 7
  s_mul_i32 s57, s57, 3200
  v_lshlrev_b32 v44, 7, v1
  v_mov_b32 v45, 0x7f000000
  v_cmp_gt_u32 vcc, 25, v1
  s_nop 1
  v_cndmask_b32 v44, v45, v44, vcc
  buffer_load_dword v46, v44, s[48:51], s57 offen
  buffer_load_dword v47, v44, s[52:55], s57 offen
concat_heads__grouped_kv_mqa__linear_kernel_hedgehog__prompt_kernel_nwt:
  s_mov_b32 s26, 0
  s_mov_b32 s27, 2
  s_mov_b32 s31, 0
concat_heads__grouped_kv_mqa__linear_kernel_hedgehog__prompt_kernel_p1_lpro:
  s_lshl_b32 s28, s23, 7
  s_add_u32 s28, s28, s20
  s_mul_i32 s29, s23, s22
  s_add_u32 s29, s29, s21
  s_add_u32 s23, s23, 1
  s_cmp_ge_u32 s23, 10
  s_cselect_b32 s23, 0, s23
  s_mov_b32 m0, s24
  s_nop 0
  buffer_load_dwordx4 v16, s[8:11], s28 offen lds
  s_add_u32 m0, m0, 1024
  s_nop 0
  buffer_load_dwordx4 v17, s[8:11], s28 offen lds
  s_add_u32 m0, m0, 1024
  s_nop 0
  buffer_load_dwordx4 v18, s[8:11], s28 offen lds
  s_add_u32 m0, m0, 1024
  s_nop 0
  buffer_load_dwordx4 v19, s[8:11], s28 offen lds
  s_mov_b32 m0, s25
  s_nop 0
  buffer_load_dwordx4 v24, s[12:15], s29 offen lds
  s_add_u32 m0, m0, 1024
  s_nop 0
  buffer_load_dwordx4 v25, s[12:15], s29 offen lds
  s_add_u32 m0, m0, 1024
  s_nop 0
  buffer_load_dwordx4 v26, s[12:15], s29 offen lds
  s_add_u32 m0, m0, 1024
  s_nop 0
  buffer_load_dwordx4 v27, s[12:15], s29 offen lds
  s_add_u32 m0, m0, 1024
  s_nop 0
  buffer_load_dwordx4 v28, s[12:15], s29 offen lds
  s_add_u32 s24, s24, 36864
  s_add_u32 s25, s25, 36864
  s_add_u32 s26, s26, 1
  s_cmp_ge_u32 s26, 4
  s_cselect_b32 s30, 147456, 0
  s_cselect_b32 s26, 0, s26
  s_sub_u32 s24, s24, s30
  s_sub_u32 s25, s25, s30
  s_sub_u32 s27, s27, 1
  s_cmp_lg_u32 s27, 0
  s_cbranch_scc1 concat_heads__grouped_kv_mqa__linear_kernel_hedgehog__prompt_kernel_p1_lpro
  s_cmp_lg_u32 s31, 0
  s_cbranch_scc1 concat_heads__grouped_kv_mqa__linear_kernel_hedgehog__prompt_kernel_p1_lpro2
  s_waitcnt vmcnt(9)
  s_barrier
  s_mov_b32 s31, 1
  s_mov_b32 s27, 2
  s_branch concat_heads__grouped_kv_mqa__linear_kernel_hedgehog__prompt_kernel_p1_lpro
concat_heads__grouped_kv_mqa__linear_kernel_hedgehog__prompt_kernel_p1_lpro2:
  s_mov_b32 s27, 6
concat_heads__grouped_kv_mqa__linear_kernel_hedgehog__prompt_kernel_p1_lloop:
  s_waitcnt vmcnt(18)
  s_barrier
  s_lshl_b32 s28, s23, 7
  s_add_u32 s28, s28, s20
  s_mul_i32 s29, s23, s22
  s_add_u32 s29, s29, s21
  s_add_u32 s23, s23, 1
  s_cmp_ge_u32 s23, 10
  s_cselect_b32 s23, 0, s23
  s_mov_b32 m0, s24
  s_nop 0
  buffer_load_dwordx4 v16, s[8:11], s28 offen lds
  s_add_u32 m0, m0, 1024
  s_nop 0
  buffer_load_dwordx4 v17, s[8:11], s28 offen lds
  s_add_u32 m0, m0, 1024
  s_nop 0
  buffer_load_dwordx4 v18, s[8:11], s28 offen lds
  s_add_u32 m0, m0, 1024
  s_nop 0
  buffer_load_dwordx4 v19, s[8:11], s28 offen lds
  s_mov_b32 m0, s25
  s_nop 0
  buffer_load_dwordx4 v24, s[12:15], s29 offen lds
  s_add_u32 m0, m0, 1024
  s_nop 0
  buffer_load_dwordx4 v25, s[12:15], s29 offen lds
  s_add_u32 m0, m0, 1024
  s_nop 0
  buffer_load_dwordx4 v26, s[12:15], s29 offen lds
  s_add_u32 m0, m0, 1024
  s_nop 0
  buffer_load_dwordx4 v27, s[12:15], s29 offen lds
  s_add_u32 m0, m0, 1024
  s_nop 0
  buffer_load_dwordx4 v28, s[12:15], s29 offen lds
  s_add_u32 s24, s24, 36864
  s_add_u32 s25, s25, 36864
  s_add_u32 s26, s26, 1
  s_cmp_ge_u32 s26, 4
  s_cselect_b32 s30, 147456, 0
  s_cselect_b32 s26, 0, s26
  s_sub_u32 s24, s24, s30
  s_sub_u32 s25, s25, s30
  s_sub_u32 s27, s27, 1
  s_cmp_lg_u32 s27, 0
  s_cbranch_scc1 concat_heads__grouped_kv_mqa__linear_kernel_hedgehog__prompt_kernel_p1_lloop
  s_waitcnt vmcnt(18)
  s_barrier
  s_cmp_lg_u32 s40, 0
  s_cbranch_scc1 concat_heads__grouped_kv_mqa__linear_kernel_hedgehog__prompt_kernel_tx6
  s_mov_b32 s16, s84
  s_and_b32 s17, s85, 0xffff
  s_mov_b32 s18, 25600
  s_mov_b32 s19, 0x00020000
  s_mul_i32 s57, s3, 7168
  s_add_u32 s58, s57, 73728
  s_mov_b32 m0, s58
  s_add_u32 s58, s58, 1024
  buffer_load_dwordx4 v40, s[16:19], s57 offen lds
  s_add_u32 s57, s57, 1024
  s_mov_b32 m0, s58
  s_add_u32 s58, s58, 1024
  buffer_load_dwordx4 v40, s[16:19], s57 offen lds
  s_add_u32 s57, s57, 1024
  s_mov_b32 m0, s58
  s_add_u32 s58, s58, 1024
  buffer_load_dwordx4 v40, s[16:19], s57 offen lds
  s_add_u32 s57, s57, 1024
  s_mov_b32 m0, s58
  s_add_u32 s58, s58, 1024
  buffer_load_dwordx4 v40, s[16:19], s57 offen lds
  s_add_u32 s57, s57, 1024
  s_mov_b32 m0, s58
  s_add_u32 s58, s58, 1024
  buffer_load_dwordx4 v40, s[16:19], s57 offen lds
  s_add_u32 s57, s57, 1024
  s_mov_b32 m0, s58
  s_add_u32 s58, s58, 1024
  buffer_load_dwordx4 v40, s[16:19], s57 offen lds
  s_add_u32 s57, s57, 1024
  s_mov_b32 m0, s58
  s_add_u32 s58, s58, 1024
  buffer_load_dwordx4 v40, s[16:19], s57 offen lds
  s_add_u32 s57, s57, 1024
concat_heads__grouped_kv_mqa__linear_kernel_hedgehog__prompt_kernel_tx6:
  s_cmp_eq_u32 s40, 0
  s_cbranch_scc1 concat_heads__grouped_kv_mqa__linear_kernel_hedgehog__prompt_kernel_p1_tw7a
  s_waitcnt vmcnt(9)
  s_branch concat_heads__grouped_kv_mqa__linear_kernel_hedgehog__prompt_kernel_p1_tw7b
concat_heads__grouped_kv_mqa__linear_kernel_hedgehog__prompt_kernel_p1_tw7a:
  s_waitcnt vmcnt(16)
concat_heads__grouped_kv_mqa__linear_kernel_hedgehog__prompt_kernel_p1_tw7b:
  s_barrier
  s_cmp_lg_u32 s40, 0
  s_cbranch_scc1 concat_heads__grouped_kv_mqa__linear_kernel_hedgehog__prompt_kernel_tx7
  s_mov_b32 s16, s86
  s_and_b32 s17, s87, 0xffff
  s_mov_b32 s18, 25600
  s_mov_b32 s19, 0x00020000
  s_mul_i32 s57, s3, 7168
  s_add_u32 s58, s57, 110592
  s_mov_b32 m0, s58
  s_add_u32 s58, s58, 1024
  buffer_load_dwordx4 v40, s[16:19], s57 offen lds
  s_add_u32 s57, s57, 1024
  s_mov_b32 m0, s58
  s_add_u32 s58, s58, 1024
  buffer_load_dwordx4 v40, s[16:19], s57 offen lds
  s_add_u32 s57, s57, 1024
  s_mov_b32 m0, s58
  s_add_u32 s58, s58, 1024
  buffer_load_dwordx4 v40, s[16:19], s57 offen lds
  s_add_u32 s57, s57, 1024
  s_mov_b32 m0, s58
  s_add_u32 s58, s58, 1024
  buffer_load_dwordx4 v40, s[16:19], s57 offen lds
  s_add_u32 s57, s57, 1024
  s_mov_b32 m0, s58
  s_add_u32 s58, s58, 1024
  buffer_load_dwordx4 v40, s[16:19], s57 offen lds
  s_add_u32 s57, s57, 1024
  s_mov_b32 m0, s58
  s_add_u32 s58, s58, 1024
  buffer_load_dwordx4 v40, s[16:19], s57 offen lds
  s_add_u32 s57, s57, 1024
  s_mov_b32 m0, s58
  s_add_u32 s58, s58, 1024
  buffer_load_dwordx4 v40, s[16:19], s57 offen lds
  s_add_u32 s57, s57, 1024
  s_mov_b32 s8, s32
  s_and_b32 s9, s33, 0xffff
  s_mov_b32 s10, 2621440
  s_mov_b32 s11, 0x20000
  s_lshl_b32 s50, s41, 7
  s_lshl_b32 s51, s42, 5
  s_add_u32 s50, s50, s51
  s_mul_i32 s51, s50, 1280
  s_mul_i32 s52, s3, 320
  s_add_u32 s51, s51, s52
  v_and_b32 v174, 15, v1
  v_mul_u32_u24 v174, 1280, v174
  v_lshrrev_b32 v175, 4, v1
  v_lshl_add_u32 v174, v175, 4, v174
  buffer_load_dwordx4 v[196:199], v174, s[8:11], s51 offen offset:0
  buffer_load_dwordx4 v[200:203], v174, s[8:11], s51 offen offset:64
  buffer_load_dwordx4 v[204:207], v174, s[8:11], s51 offen offset:128
  buffer_load_dwordx4 v[208:211], v174, s[8:11], s51 offen offset:192
  buffer_load_dwordx4 v[212:215], v174, s[8:11], s51 offen offset:256
  s_add_u32 s51, s51, 20480
  buffer_load_dwordx4 v[216:219], v174, s[8:11], s51 offen offset:0
  buffer_load_dwordx4 v[220:223], v174, s[8:11], s51 offen offset:64
  buffer_load_dwordx4 v[224:227], v174, s[8:11], s51 offen offset:128
  buffer_load_dwordx4 v[228:231], v174, s[8:11], s51 offen offset:192
  buffer_load_dwordx4 v[232:235], v174, s[8:11], s51 offen offset:256
concat_heads__grouped_kv_mqa__linear_kernel_hedgehog__prompt_kernel_tx7:
  s_cmp_eq_u32 s40, 0
  s_cbranch_scc1 concat_heads__grouped_kv_mqa__linear_kernel_hedgehog__prompt_kernel_p1_tw8a
  s_waitcnt vmcnt(0)
  s_branch concat_heads__grouped_kv_mqa__linear_kernel_hedgehog__prompt_kernel_p1_tw8b
concat_heads__grouped_kv_mqa__linear_kernel_hedgehog__prompt_kernel_p1_tw8a:
  s_waitcnt vmcnt(24)
concat_heads__grouped_kv_mqa__linear_kernel_hedgehog__prompt_kernel_p1_tw8b:
  s_barrier
  s_barrier
  s_waitcnt vmcnt(0)
  s_barrier
  s_cmp_lg_u32 s40, 0
  s_cbranch_scc1 concat_heads__grouped_kv_mqa__linear_kernel_hedgehog__prompt_kernel_lnkv
  s_mov_b32 s16, s4
  s_and_b32 s17, s5, 0xffff
  s_mov_b32 s18, 268435456
  s_mov_b32 s19, 0x00020000
  s_mov_b32 s99, 73728
  s_mov_b32 s97, 110592
  v_lshrrev_b32 v174, 4, v1
  v_lshlrev_b32 v174, 3, v174
  v_bfe_u32 v175, v1, 2, 2
  v_add_u32 v174, v174, v175
  v_mul_u32_u24 v174, 40, v174
  s_mul_i32 s57, s3, 6400
  v_add_u32 v174, s57, v174
  v_and_b32 v175, 3, v1
  v_lshlrev_b32 v176, 4, v175
  v_cmp_gt_u32 vcc, 3, v175
  s_nop 1
  v_cndmask_b32 v179, 0, v176, vcc
  v_add3_u32 v180, v174, v179, s99
  v_cmp_gt_u32 vcc, 2, v175
  s_nop 1
  v_cndmask_b32 v179, 0, v176, vcc
  v_add3_u32 v181, v174, v179, s99
  v_add_u32 v181, 8, v181
  v_lshlrev_b32 v179, 3, v175
  v_add3_u32 v182, v174, v179, s97
  v_add_u32 v183, s97, v174
  v_add_u32 v183, 32, v183
  ds_read_b64_tr_b16 v[96:97], v180 offset:0
  ds_read_b64_tr_b16 v[100:101], v181 offset:0
  ds_read_b64_tr_b16 v[104:105], v182 offset:0
  ds_read_b64_tr_b16 v[108:109], v183 offset:0
  ds_read_b64_tr_b16 v[98:99], v180 offset:160
  ds_read_b64_tr_b16 v[102:103], v181 offset:160
  ds_read_b64_tr_b16 v[106:107], v182 offset:160
  ds_read_b64_tr_b16 v[110:111], v183 offset:160
  ds_read_b64_tr_b16 v[112:113], v180 offset:1280
  ds_read_b64_tr_b16 v[116:117], v181 offset:1280
  ds_read_b64_tr_b16 v[120:121], v182 offset:1280
  ds_read_b64_tr_b16 v[124:125], v183 offset:1280
  ds_read_b64_tr_b16 v[114:115], v180 offset:1440
  ds_read_b64_tr_b16 v[118:119], v181 offset:1440
  ds_read_b64_tr_b16 v[122:123], v182 offset:1440
  ds_read_b64_tr_b16 v[126:127], v183 offset:1440
  ds_read_b64_tr_b16 v[236:237], v180 offset:5120
  ds_read_b64_tr_b16 v[240:241], v181 offset:5120
  ds_read_b64_tr_b16 v[244:245], v182 offset:5120
  ds_read_b64_tr_b16 v[248:249], v183 offset:5120
  ds_read_b64_tr_b16 v[238:239], v180 offset:5280
  ds_read_b64_tr_b16 v[242:243], v181 offset:5280
  ds_read_b64_tr_b16 v[246:247], v182 offset:5280
  ds_read_b64_tr_b16 v[250:251], v183 offset:5280
  s_waitcnt vmcnt(0) lgkmcnt(0)
  v_mfma_f32_16x16x32_bf16 v[48:51], v[96:99], v[196:199], 0
  v_mfma_f32_16x16x32_bf16 v[56:59], v[100:103], v[196:199], 0
  v_mfma_f32_16x16x32_bf16 v[64:67], v[196:199], v[104:107], 0
  v_mfma_f32_16x16x32_bf16 v[68:71], v[196:199], v[108:111], 0
  v_mfma_f32_16x16x32_bf16 v[52:55], v[96:99], v[216:219], 0
  v_mfma_f32_16x16x32_bf16 v[60:63], v[100:103], v[216:219], 0
  v_mfma_f32_16x16x32_bf16 v[72:75], v[216:219], v[104:107], 0
  v_mfma_f32_16x16x32_bf16 v[76:79], v[216:219], v[108:111], 0
  v_mfma_f32_16x16x32_bf16 v[48:51], v[112:115], v[200:203], v[48:51]
  v_mfma_f32_16x16x32_bf16 v[56:59], v[116:119], v[200:203], v[56:59]
  v_mfma_f32_16x16x32_bf16 v[64:67], v[200:203], v[120:123], v[64:67]
  v_mfma_f32_16x16x32_bf16 v[68:71], v[200:203], v[124:127], v[68:71]
  v_mfma_f32_16x16x32_bf16 v[52:55], v[112:115], v[220:223], v[52:55]
  v_mfma_f32_16x16x32_bf16 v[60:63], v[116:119], v[220:223], v[60:63]
  v_mfma_f32_16x16x32_bf16 v[72:75], v[220:223], v[120:123], v[72:75]
  v_mfma_f32_16x16x32_bf16 v[76:79], v[220:223], v[124:127], v[76:79]
  v_mfma_f32_16x16x32_bf16 v[48:51], v[236:239], v[212:215], v[48:51]
  v_mfma_f32_16x16x32_bf16 v[56:59], v[240:243], v[212:215], v[56:59]
  v_mfma_f32_16x16x32_bf16 v[64:67], v[212:215], v[244:247], v[64:67]
  v_mfma_f32_16x16x32_bf16 v[68:71], v[212:215], v[248:251], v[68:71]
  v_mfma_f32_16x16x32_bf16 v[52:55], v[236:239], v[232:235], v[52:55]
  v_mfma_f32_16x16x32_bf16 v[60:63], v[240:243], v[232:235], v[60:63]
  v_mfma_f32_16x16x32_bf16 v[72:75], v[232:235], v[244:247], v[72:75]
  v_mfma_f32_16x16x32_bf16 v[76:79], v[232:235], v[248:251], v[76:79]
  s_nop 3
  ds_read_b64_tr_b16 v[128:129], v180 offset:2560
  ds_read_b64_tr_b16 v[132:133], v181 offset:2560
  ds_read_b64_tr_b16 v[136:137], v182 offset:2560
  ds_read_b64_tr_b16 v[140:141], v183 offset:2560
  ds_read_b64_tr_b16 v[130:131], v180 offset:2720
  ds_read_b64_tr_b16 v[134:135], v181 offset:2720
  ds_read_b64_tr_b16 v[138:139], v182 offset:2720
  ds_read_b64_tr_b16 v[142:143], v183 offset:2720
  ds_read_b64_tr_b16 v[144:145], v180 offset:3840
  ds_read_b64_tr_b16 v[148:149], v181 offset:3840
  ds_read_b64_tr_b16 v[152:153], v182 offset:3840
  ds_read_b64_tr_b16 v[156:157], v183 offset:3840
  ds_read_b64_tr_b16 v[146:147], v180 offset:4000
  ds_read_b64_tr_b16 v[150:151], v181 offset:4000
  ds_read_b64_tr_b16 v[154:155], v182 offset:4000
  ds_read_b64_tr_b16 v[158:159], v183 offset:4000
  s_waitcnt lgkmcnt(0)
  v_mfma_f32_16x16x32_bf16 v[48:51], v[128:131], v[204:207], v[48:51]
  v_mfma_f32_16x16x32_bf16 v[56:59], v[132:135], v[204:207], v[56:59]
  v_mfma_f32_16x16x32_bf16 v[64:67], v[204:207], v[136:139], v[64:67]
  v_mfma_f32_16x16x32_bf16 v[68:71], v[204:207], v[140:143], v[68:71]
  v_mfma_f32_16x16x32_bf16 v[52:55], v[128:131], v[224:227], v[52:55]
  v_mfma_f32_16x16x32_bf16 v[60:63], v[132:135], v[224:227], v[60:63]
  v_mfma_f32_16x16x32_bf16 v[72:75], v[224:227], v[136:139], v[72:75]
  v_mfma_f32_16x16x32_bf16 v[76:79], v[224:227], v[140:143], v[76:79]
  v_mfma_f32_16x16x32_bf16 v[48:51], v[144:147], v[208:211], v[48:51]
  v_mfma_f32_16x16x32_bf16 v[56:59], v[148:151], v[208:211], v[56:59]
  v_mfma_f32_16x16x32_bf16 v[64:67], v[208:211], v[152:155], v[64:67]
  v_mfma_f32_16x16x32_bf16 v[68:71], v[208:211], v[156:159], v[68:71]
  v_mfma_f32_16x16x32_bf16 v[52:55], v[144:147], v[228:231], v[52:55]
  v_mfma_f32_16x16x32_bf16 v[60:63], v[148:151], v[228:231], v[60:63]
  v_mfma_f32_16x16x32_bf16 v[72:75], v[228:231], v[152:155], v[72:75]
  v_mfma_f32_16x16x32_bf16 v[76:79], v[228:231], v[156:159], v[76:79]
  s_nop 7
  v_lshlrev_b32 v174, 4, v1
  s_lshl_b32 s57, s3, 13
  v_add_u32 v175, s57, v174
  ds_write_b128 v175, v[48:51] offset:0
  ds_write_b128 v175, v[52:55] offset:1024
  ds_write_b128 v175, v[56:59] offset:2048
  ds_write_b128 v175, v[60:63] offset:3072
  ds_write_b128 v175, v[64:67] offset:4096
  ds_write_b128 v175, v[68:71] offset:5120
  ds_write_b128 v175, v[72:75] offset:6144
  ds_write_b128 v175, v[76:79] offset:7168
  s_waitcnt lgkmcnt(0)
  s_barrier
  s_lshl_b32 s57, s3, 10
  s_sub_u32 s58, s3, 2
  s_lshl_b32 s58, s58, 11
  s_add_u32 s58, s58, 4096
  s_cmp_lt_u32 s3, 2
  s_cselect_b32 s57, s57, s58
  s_movk_i32 s58, 1024
  s_cselect_b32 s58, 2048, s58
  v_add_u32 v175, s57, v174
  v_add_u32 v176, s58, v175
  ds_read_b128 v[96:99], v175 offset:0
  ds_read_b128 v[100:103], v176 offset:0
  ds_read_b128 v[104:107], v175 offset:8192
  ds_read_b128 v[108:111], v176 offset:8192
  ds_read_b128 v[112:115], v175 offset:16384
  ds_read_b128 v[116:119], v176 offset:16384
  ds_read_b128 v[120:123], v175 offset:24576
  ds_read_b128 v[124:127], v176 offset:24576
  s_waitcnt lgkmcnt(0)
  v_add_f32 v96, v96, v104
  v_add_f32 v112, v112, v120
  v_add_f32 v97, v97, v105
  v_add_f32 v113, v113, v121
  v_add_f32 v98, v98, v106
  v_add_f32 v114, v114, v122
  v_add_f32 v99, v99, v107
  v_add_f32 v115, v115, v123
  v_add_f32 v100, v100, v108
  v_add_f32 v116, v116, v124
  v_add_f32 v101, v101, v109
  v_add_f32 v117, v117, v125
  v_add_f32 v102, v102, v110
  v_add_f32 v118, v118, v126
  v_add_f32 v103, v103, v111
  v_add_f32 v119, v119, v127
  v_add_f32 v96, v96, v112
  v_add_f32 v97, v97, v113
  v_add_f32 v98, v98, v114
  v_add_f32 v99, v99, v115
  v_add_f32 v100, v100, v116
  v_add_f32 v101, v101, v117
  v_add_f32 v102, v102, v118
  v_add_f32 v103, v103, v119
  v_cvt_pk_bf16_f32 v104, v96, v97
  v_cvt_pk_bf16_f32 v105, v98, v99
  v_cvt_pk_bf16_f32 v106, v100, v101
  v_cvt_pk_bf16_f32 v107, v102, v103
  s_lshl_b32 s50, s41, 2
  s_add_u32 s50, s50, s42
  s_mul_i32 s51, s50, 3584
  s_add_u32 s51, s51, 3145728
  s_cmp_ge_u32 s3, 2
  s_cbranch_scc1 concat_heads__grouped_kv_mqa__linear_kernel_hedgehog__prompt_kernel_vfin
  v_and_b32 v174, 15, v1
  s_lshl_b32 s52, s3, 4
  v_add_u32 v174, s52, v174
  v_lshrrev_b32 v175, 4, v1
  v_cmp_gt_u32 vcc, 2, v175
  s_nop 1
  v_cndmask_b32 v108, 0, v106, vcc
  v_cndmask_b32 v109, 0, v107, vcc
  v_cmp_gt_u32 vcc, 3, v175
  s_nop 1
  v_cndmask_b32 v110, 0, v104, vcc
  v_cndmask_b32 v111, 0, v105, vcc
  v_mov_b32 v112, 0
  v_dot2c_f32_bf16 v112, v108, v108
  v_dot2c_f32_bf16 v112, v109, v109
  v_dot2c_f32_bf16 v112, v110, v110
  v_dot2c_f32_bf16 v112, v111, v111
  s_nop 2
  v_mov_b32 v113, v112
  s_nop 1
  v_permlane16_swap_b32 v112, v113
  s_nop 1
  v_add_f32 v112, v112, v113
  v_mov_b32 v113, v112
  s_nop 1
  v_permlane32_swap_b32 v112, v113
  s_nop 1
  v_add_f32 v112, v112, v113
  s_nop 1
  v_max_f32_dpp v112, v112, v112 row_shr:1 row_mask:0xf bank_mask:0xf
  s_nop 1
  v_max_f32_dpp v112, v112, v112 row_shr:2 row_mask:0xf bank_mask:0xf
  s_nop 1
  v_max_f32_dpp v112, v112, v112 row_shr:4 row_mask:0xf bank_mask:0xf
  s_nop 1
  v_max_f32_dpp v112, v112, v112 row_shr:8 row_mask:0xf bank_mask:0xf
  v_lshlrev_b32 v176, 5, v175
  v_add_u32 v176, v176, v174
  v_lshlrev_b32 v176, 4, v176
  v_cmp_gt_u32 vcc, 2, v175
  s_and_saveexec_b64 s[54:55], vcc
  buffer_store_dwordx4 v[104:107], v176, s[16:19], s51 offen sc0 sc1
  s_andn2_b64 exec, s[54:55], exec
  v_cmp_eq_u32 vcc, 3, v175
  s_nop 1
  v_mov_b32 v114, 0x3f803f80
  v_mov_b32 v115, 0
  v_cndmask_b32 v104, v104, v114, vcc
  v_cndmask_b32 v105, v105, v115, vcc
  v_subrev_u32 v177, 2, v175
  v_lshlrev_b32 v177, 5, v177
  v_add_u32 v177, v177, v174
  v_lshlrev_b32 v177, 3, v177
  buffer_store_dwordx2 v[104:105], v177, s[16:19], s51 offen offset:3072 sc0 sc1
  s_mov_b64 exec, s[54:55]
  s_lshl_b32 s52, s50, 1
  s_add_u32 s52, s52, s3
  s_lshl_b32 s52, s52, 2
  s_add_u32 s52, s52, 3407872
  s_mov_b64 exec, 0x8000
  v_mov_b32 v113, 0
  buffer_store_dword v112, v113, s[16:19], s52 offen sc0 sc1
  s_mov_b64 exec, -1
  s_branch concat_heads__grouped_kv_mqa__linear_kernel_hedgehog__prompt_kernel_adone
concat_heads__grouped_kv_mqa__linear_kernel_hedgehog__prompt_kernel_vfin:
  v_and_b32 v174, 15, v1
  v_lshrrev_b32 v175, 4, v1
  v_cmp_gt_u32 vcc, 4, v174
  s_nop 1
  v_cndmask_b32 v106, 0, v106, vcc
  v_cndmask_b32 v107, 0, v107, vcc
  v_cmp_eq_u32 vcc, 4, v174
  v_mov_b32 v114, 0x3f803f80
  s_nop 0
  v_cndmask_b32 v106, v106, v114, vcc
  v_cndmask_b32 v107, v107, v114, vcc
  v_and_b32 v176, 1, v175
  v_lshlrev_b32 v176, 5, v176
  v_add_u32 v176, v176, v174
  v_lshlrev_b32 v176, 4, v176
  v_lshrrev_b32 v177, 1, v175
  v_lshl_add_u32 v176, v177, 3, v176
  s_sub_u32 s52, s3, 2
  s_lshl_b32 s52, s52, 10
  s_add_u32 s52, s52, s51
  buffer_store_dwordx2 v[104:105], v176, s[16:19], s52 offen offset:1024 sc0 sc1
  buffer_store_dwordx2 v[106:107], v176, s[16:19], s52 offen offset:1280 sc0 sc1
concat_heads__grouped_kv_mqa__linear_kernel_hedgehog__prompt_kernel_adone:
  s_barrier
  s_waitcnt vmcnt(0)
  s_barrier
  s_branch concat_heads__grouped_kv_mqa__linear_kernel_hedgehog__prompt_kernel_lp2
concat_heads__grouped_kv_mqa__linear_kernel_hedgehog__prompt_kernel_lnkv:
  s_barrier
  s_barrier
  s_barrier
concat_heads__grouped_kv_mqa__linear_kernel_hedgehog__prompt_kernel_lp2:
  s_sub_u32 s3, s100, 4
  v_mov_b32 v2, v1
  s_mov_b32 s38, -1
  s_mov_b32 s39, 0
  v_lshlrev_b32 v120, 4, v2
  v_lshlrev_b32 v121, 3, v2
  s_mov_b32 s8, s4
  s_and_b32 s9, s5, 0xffff
  s_mov_b32 s10, 268435456
  s_mov_b32 s11, 0x00020000
  s_setprio 2
  s_mov_b32 s44, s6
  s_and_b32 s45, s7, 0xffff
  s_mov_b32 s46, 256
  s_mov_b32 s47, 0x00020000
  s_cmp_lg_u32 s3, 0
  s_cbranch_scc1 concat_heads__grouped_kv_mqa__linear_kernel_hedgehog__prompt_kernel_h0j
  s_cmp_lg_u32 s40, 0
  s_cbranch_scc1 concat_heads__grouped_kv_mqa__linear_kernel_hedgehog__prompt_kernel_nf2
  s_lshl_b32 s26, s41, 2
  s_add_u32 s26, s26, s42
  s_lshl_b32 s26, s26, 2
  s_mov_b64 exec, 1
  v_mov_b32 v44, s26
  v_mov_b32 v45, 1
  buffer_store_dword v45, v44, s[44:47], 0 offen sc0 sc1
  s_mov_b64 exec, -1
concat_heads__grouped_kv_mqa__linear_kernel_hedgehog__prompt_kernel_nf2:
  v_lshlrev_b32 v46, 2, v1
  s_mov_b32 s30, 0
concat_heads__grouped_kv_mqa__linear_kernel_hedgehog__prompt_kernel_pa:
  buffer_load_dword v47, v46, s[44:47], 0 offen sc1
  s_waitcnt vmcnt(0)
  v_cmp_le_u32 vcc, 1, v47
  s_add_u32 s30, s30, 1
  s_cmp_eq_u64 vcc, -1
  s_cbranch_scc1 concat_heads__grouped_kv_mqa__linear_kernel_hedgehog__prompt_kernel_pa_d
  s_cmp_gt_u32 s30, 1000000
  s_cbranch_scc1 concat_heads__grouped_kv_mqa__linear_kernel_hedgehog__prompt_kernel_pa_d
  s_sleep 3
  s_branch concat_heads__grouped_kv_mqa__linear_kernel_hedgehog__prompt_kernel_pa
concat_heads__grouped_kv_mqa__linear_kernel_hedgehog__prompt_kernel_pa_d:
concat_heads__grouped_kv_mqa__linear_kernel_hedgehog__prompt_kernel_h0j:
  s_barrier
  s_mul_i32 s20, s3, 57344
  s_add_u32 s20, s20, 3145728
  s_mul_i32 s22, s3, 28672
  s_mov_b32 s21, s22
  s_mov_b32 m0, s21
  s_nop 0
  buffer_load_dwordx4 v120, s[8:11], s20 offen offset:0 lds
  buffer_load_dwordx4 v120, s[8:11], s20 offen offset:1024 lds
  buffer_load_dwordx4 v120, s[8:11], s20 offen offset:2048 lds
  s_mov_b64 exec, s[38:39]
  buffer_load_dwordx4 v120, s[8:11], s20 offen offset:3072 lds
  s_mov_b64 exec, -1
  s_add_u32 s20, s20, 3584
  s_add_u32 s21, s21, 3584
  s_lshr_b32 s12, s2, 2
  s_lshl_b32 s12, s12, 5
  s_and_b32 s13, s2, 3
  s_lshl_b32 s13, s13, 3
  s_add_u32 s12, s12, s13
  s_mul_i32 s12, s12, 1536
  s_add_u32 s12, s12, 0
  s_mul_i32 s13, s3, 3072
  s_add_u32 s12, s12, s13
  s_add_u32 s13, s13, 114688
  s_mov_b32 m0, s13
  s_nop 0
  buffer_load_dwordx4 v120, s[8:11], s12 offen offset:0 lds
  buffer_load_dwordx4 v120, s[8:11], s12 offen offset:1024 lds
  buffer_load_dwordx4 v120, s[8:11], s12 offen offset:2048 lds
  s_mov_b32 m0, 146944
  s_mov_b32 s12, 3407872
  s_mov_b64 exec, s[38:39]
  buffer_load_dwordx4 v120, s[8:11], s12 offen lds
  s_mov_b64 exec, -1
  s_mov_b32 m0, s21
  s_nop 0
  buffer_load_dwordx4 v120, s[8:11], s20 offen offset:0 lds
  buffer_load_dwordx4 v120, s[8:11], s20 offen offset:1024 lds
  buffer_load_dwordx4 v120, s[8:11], s20 offen offset:2048 lds
  s_mov_b64 exec, s[38:39]
  buffer_load_dwordx4 v120, s[8:11], s20 offen offset:3072 lds
  s_mov_b64 exec, -1
  s_add_u32 s20, s20, 3584
  s_add_u32 s21, s21, 3584
  s_waitcnt vmcnt(0)
  s_barrier
  s_mov_b32 s25, 6
concat_heads__grouped_kv_mqa__linear_kernel_hedgehog__prompt_kernel_hl0:
  s_mov_b32 m0, s21
  s_nop 0
  buffer_load_dwordx4 v120, s[8:11], s20 offen offset:0 lds
  buffer_load_dwordx4 v120, s[8:11], s20 offen offset:1024 lds
  buffer_load_dwordx4 v120, s[8:11], s20 offen offset:2048 lds
  s_mov_b64 exec, s[38:39]
  buffer_load_dwordx4 v120, s[8:11], s20 offen offset:3072 lds
  s_mov_b64 exec, -1
  s_add_u32 s20, s20, 3584
  s_add_u32 s21, s21, 3584
  s_sub_u32 s25, s25, 1
  s_cmp_lg_u32 s25, 0
  s_cbranch_scc1 concat_heads__grouped_kv_mqa__linear_kernel_hedgehog__prompt_kernel_hl0
  s_cmp_lg_u32 s3, 0
  s_cbranch_scc1 concat_heads__grouped_kv_mqa__linear_kernel_hedgehog__prompt_kernel_h0b
  s_cmp_eq_u32 s40, 0
  s_cbranch_scc1 concat_heads__grouped_kv_mqa__linear_kernel_hedgehog__prompt_kernel_h0b
  v_mov_b32 v5, 19930112
  s_mov_b64 exec, 1
  v_mov_b32 v4, 1
  buffer_atomic_add v4, v5, s[8:11], 0 offen sc1
  s_mov_b64 exec, -1
concat_heads__grouped_kv_mqa__linear_kernel_hedgehog__prompt_kernel_h0b:
  v_mov_b32 v4, 0
  v_mov_b32 v5, 0
  v_mov_b32 v6, 0
  v_mov_b32 v7, 0
  s_lshl_b32 s29, s3, 9
  s_add_u32 s29, s29, 134656
  v_add_u32 v40, s29, v121
  ds_write_b64 v40, v[4:5]
  s_waitcnt vmcnt(8) lgkmcnt(0)
  s_barrier
  s_mov_b32 s21, s22
  s_mov_b32 m0, s21
  s_nop 0
  buffer_load_dwordx4 v120, s[8:11], s20 offen offset:0 lds
  buffer_load_dwordx4 v120, s[8:11], s20 offen offset:1024 lds
  buffer_load_dwordx4 v120, s[8:11], s20 offen offset:2048 lds
  s_mov_b64 exec, s[38:39]
  buffer_load_dwordx4 v120, s[8:11], s20 offen offset:3072 lds
  s_mov_b64 exec, -1
  s_add_u32 s20, s20, 3584
  s_add_u32 s21, s21, 3584
  s_mov_b32 m0, s21
  s_nop 0
  buffer_load_dwordx4 v120, s[8:11], s20 offen offset:0 lds
  buffer_load_dwordx4 v120, s[8:11], s20 offen offset:1024 lds
  buffer_load_dwordx4 v120, s[8:11], s20 offen offset:2048 lds
  s_mov_b64 exec, s[38:39]
  buffer_load_dwordx4 v120, s[8:11], s20 offen offset:3072 lds
  s_mov_b64 exec, -1
  s_add_u32 s20, s20, 3584
  s_add_u32 s21, s21, 3584
  v_mov_b32 v5, 19930112
  s_mov_b32 s30, 0
  s_mov_b64 exec, 1
concat_heads__grouped_kv_mqa__linear_kernel_hedgehog__prompt_kernel_pb:
  buffer_load_dword v4, v5, s[8:11], 0 offen sc1
  s_waitcnt vmcnt(0)
  v_readfirstlane_b32 s31, v4
  s_add_u32 s30, s30, 1
  s_cmp_ge_u32 s31, 192
  s_cbranch_scc1 concat_heads__grouped_kv_mqa__linear_kernel_hedgehog__prompt_kernel_pb_d
  s_cmp_gt_u32 s30, 1000000
  s_cbranch_scc1 concat_heads__grouped_kv_mqa__linear_kernel_hedgehog__prompt_kernel_pb_d
  s_sleep 1
  s_branch concat_heads__grouped_kv_mqa__linear_kernel_hedgehog__prompt_kernel_pb
concat_heads__grouped_kv_mqa__linear_kernel_hedgehog__prompt_kernel_pb_d:
  s_mov_b64 exec, -1
  s_and_b32 s26, s2, 7
  s_lshr_b32 s27, s2, 3
  s_mul_i32 s28, s26, 245760
  s_mul_i32 s29, s27, 480
  s_add_u32 s28, s28, s29
  s_mul_i32 s29, s3, 120
  s_add_u32 s28, s28, s29
  s_add_u32 s28, s28, 16777216
  v_mov_b32 v3, 0x7f000000
  v_cmp_gt_u32 vcc, 15, v2
  s_nop 1
  v_cndmask_b32 v3, v3, v121, vcc
  buffer_load_dwordx2 v[8:9], v3, s[8:11], s28 offen
  s_add_u32 s28, s28, 15360
  buffer_load_dwordx2 v[10:11], v3, s[8:11], s28 offen
  s_add_u32 s28, s28, 15360
  buffer_load_dwordx2 v[12:13], v3, s[8:11], s28 offen
  s_add_u32 s28, s28, 15360
  buffer_load_dwordx2 v[14:15], v3, s[8:11], s28 offen
  s_add_u32 s28, s28, 15360
  buffer_load_dwordx2 v[16:17], v3, s[8:11], s28 offen
  s_add_u32 s28, s28, 15360
  buffer_load_dwordx2 v[18:19], v3, s[8:11], s28 offen
  s_add_u32 s28, s28, 15360
  buffer_load_dwordx2 v[20:21], v3, s[8:11], s28 offen
  s_add_u32 s28, s28, 15360
  buffer_load_dwordx2 v[22:23], v3, s[8:11], s28 offen
  s_add_u32 s28, s28, 15360
  buffer_load_dwordx2 v[24:25], v3, s[8:11], s28 offen
  s_add_u32 s28, s28, 15360
  buffer_load_dwordx2 v[26:27], v3, s[8:11], s28 offen
  s_add_u32 s28, s28, 15360
  buffer_load_dwordx2 v[28:29], v3, s[8:11], s28 offen
  s_add_u32 s28, s28, 15360
  buffer_load_dwordx2 v[30:31], v3, s[8:11], s28 offen
  s_add_u32 s28, s28, 15360
  buffer_load_dwordx2 v[32:33], v3, s[8:11], s28 offen
  s_add_u32 s28, s28, 15360
  buffer_load_dwordx2 v[34:35], v3, s[8:11], s28 offen
  s_add_u32 s28, s28, 15360
  buffer_load_dwordx2 v[36:37], v3, s[8:11], s28 offen
  s_add_u32 s28, s28, 15360
  buffer_load_dwordx2 v[38:39], v3, s[8:11], s28 offen
  s_lshl_b32 s28, s27, 2
  s_add_u32 s28, s28, s3
  s_lshl_b32 s28, s28, 3
  s_add_u32 s28, s28, s26
  s_mul_i32 s28, s28, 2560
  s_add_u32 s28, s28, 10485760
  buffer_load_dwordx4 v[48:51], v120, s[8:11], s28 offen
  buffer_load_dwordx4 v[52:55], v120, s[8:11], s28 offen offset:1024
  buffer_load_dwordx2 v[56:57], v121, s[8:11], s28 offen offset:2048
  s_waitcnt vmcnt(3)
  v_add_f32 v8, v8, v10
  v_add_f32 v9, v9, v11
  v_add_f32 v8, v8, v12
  v_add_f32 v9, v9, v13
  v_add_f32 v8, v8, v14
  v_add_f32 v9, v9, v15
  v_add_f32 v8, v8, v16
  v_add_f32 v9, v9, v17
  v_add_f32 v8, v8, v18
  v_add_f32 v9, v9, v19
  v_add_f32 v8, v8, v20
  v_add_f32 v9, v9, v21
  v_add_f32 v8, v8, v22
  v_add_f32 v9, v9, v23
  v_add_f32 v8, v8, v24
  v_add_f32 v9, v9, v25
  v_add_f32 v8, v8, v26
  v_add_f32 v9, v9, v27
  v_add_f32 v8, v8, v28
  v_add_f32 v9, v9, v29
  v_add_f32 v8, v8, v30
  v_add_f32 v9, v9, v31
  v_add_f32 v8, v8, v32
  v_add_f32 v9, v9, v33
  v_add_f32 v8, v8, v34
  v_add_f32 v9, v9, v35
  v_add_f32 v8, v8, v36
  v_add_f32 v9, v9, v37
  v_add_f32 v8, v8, v38
  v_add_f32 v9, v9, v39
  v_cvt_pk_bf16_f32 v8, v8, v9
  s_mul_i32 s28, s26, 7680
  s_mul_i32 s29, s27, 240
  s_add_u32 s28, s28, s29
  s_mul_i32 s29, s3, 60
  s_add_u32 s28, s28, s29
  s_add_u32 s28, s28, 18874368
  v_mov_b32 v3, 0x7f000000
  v_lshlrev_b32 v4, 2, v2
  v_cmp_gt_u32 vcc, 15, v2
  s_nop 1
  v_cndmask_b32 v3, v3, v4, vcc
  buffer_store_dword v8, v3, s[8:11], s28 offen sc0 sc1
  s_waitcnt vmcnt(0)
  s_barrier

  s_lshl_b32 s29, s26, 7
  s_add_u32 s29, s29, 19922944
  v_mov_b32 v5, s29
  s_cmp_lg_u32 s3, 0
  s_cbranch_scc1 concat_heads__grouped_kv_mqa__linear_kernel_hedgehog__prompt_kernel_noat
  s_mov_b64 exec, 1
  v_mov_b32 v4, 1
  buffer_atomic_add v4, v5, s[8:11], 0 offen sc1
  s_mov_b64 exec, -1
concat_heads__grouped_kv_mqa__linear_kernel_hedgehog__prompt_kernel_noat:
  s_mov_b32 m0, s21
  s_nop 0
  buffer_load_dwordx4 v120, s[8:11], s20 offen offset:0 lds
  buffer_load_dwordx4 v120, s[8:11], s20 offen offset:1024 lds
  buffer_load_dwordx4 v120, s[8:11], s20 offen offset:2048 lds
  s_mov_b64 exec, s[38:39]
  buffer_load_dwordx4 v120, s[8:11], s20 offen offset:3072 lds
  s_mov_b64 exec, -1
  s_add_u32 s20, s20, 3584
  s_add_u32 s21, s21, 3584
  s_mov_b32 m0, s21
  s_nop 0
  buffer_load_dwordx4 v120, s[8:11], s20 offen offset:0 lds
  buffer_load_dwordx4 v120, s[8:11], s20 offen offset:1024 lds
  buffer_load_dwordx4 v120, s[8:11], s20 offen offset:2048 lds
  s_mov_b64 exec, s[38:39]
  buffer_load_dwordx4 v120, s[8:11], s20 offen offset:3072 lds
  s_mov_b64 exec, -1
  s_add_u32 s20, s20, 3584
  s_add_u32 s21, s21, 3584
  s_mov_b32 m0, s21
  s_nop 0
  buffer_load_dwordx4 v120, s[8:11], s20 offen offset:0 lds
  buffer_load_dwordx4 v120, s[8:11], s20 offen offset:1024 lds
  buffer_load_dwordx4 v120, s[8:11], s20 offen offset:2048 lds
  s_mov_b64 exec, s[38:39]
  buffer_load_dwordx4 v120, s[8:11], s20 offen offset:3072 lds
  s_mov_b64 exec, -1
  s_add_u32 s20, s20, 3584
  s_add_u32 s21, s21, 3584
  s_mov_b32 m0, s21
  s_nop 0
  buffer_load_dwordx4 v120, s[8:11], s20 offen offset:0 lds
  buffer_load_dwordx4 v120, s[8:11], s20 offen offset:1024 lds
  buffer_load_dwordx4 v120, s[8:11], s20 offen offset:2048 lds
  s_mov_b64 exec, s[38:39]
  buffer_load_dwordx4 v120, s[8:11], s20 offen offset:3072 lds
  s_mov_b64 exec, -1
  s_add_u32 s20, s20, 3584
  s_add_u32 s21, s21, 3584
  v_lshlrev_b32 v20, 16, v48
  v_and_b32 v21, 0xffff0000, v48
  v_lshlrev_b32 v22, 16, v49
  v_and_b32 v23, 0xffff0000, v49
  v_lshlrev_b32 v24, 16, v50
  v_and_b32 v25, 0xffff0000, v50
  v_lshlrev_b32 v26, 16, v51
  v_and_b32 v27, 0xffff0000, v51
  v_lshlrev_b32 v28, 16, v52
  v_and_b32 v29, 0xffff0000, v52
  v_lshlrev_b32 v30, 16, v53
  v_and_b32 v31, 0xffff0000, v53
  v_lshlrev_b32 v32, 16, v54
  v_and_b32 v33, 0xffff0000, v54
  v_lshlrev_b32 v34, 16, v55
  v_and_b32 v35, 0xffff0000, v55
  v_lshlrev_b32 v36, 16, v56
  v_and_b32 v37, 0xffff0000, v56
  v_lshlrev_b32 v38, 16, v57
  v_and_b32 v39, 0xffff0000, v57
  s_mov_b32 s98, 0x3fb8aa3b
  v_max3_f32 v60, v20, v21, v22
  v_min3_f32 v61, v20, v21, v22
  v_max3_f32 v60, v60, v23, v24
  v_min3_f32 v61, v61, v23, v24
  v_max3_f32 v60, v60, v25, v26
  v_min3_f32 v61, v61, v25, v26
  v_max3_f32 v60, v60, v27, v28
  v_min3_f32 v61, v61, v27, v28
  v_max3_f32 v60, v60, v29, v30
  v_min3_f32 v61, v61, v29, v30
  v_max3_f32 v60, v60, v31, v32
  v_min3_f32 v61, v61, v31, v32
  v_max3_f32 v60, v60, v33, v34
  v_min3_f32 v61, v61, v33, v34
  v_max3_f32 v60, v60, v35, v36
  v_min3_f32 v61, v61, v35, v36
  v_max3_f32 v60, v60, v37, v38
  v_min3_f32 v61, v61, v37, v38
  v_max_f32 v60, v60, v39
  v_min_f32 v61, v61, v39
  v_mul_f32 v60, 0xbfb8aa3b, v60
  v_mul_f32 v61, 0x3fb8aa3b, v61
  v_fma_f32 v40, -v20, s98, v61
  v_fma_f32 v20, v20, s98, v60
  v_fma_f32 v41, -v21, s98, v61
  v_fma_f32 v21, v21, s98, v60
  v_fma_f32 v42, -v22, s98, v61
  v_fma_f32 v22, v22, s98, v60
  v_fma_f32 v43, -v23, s98, v61
  v_fma_f32 v23, v23, s98, v60
  v_fma_f32 v44, -v24, s98, v61
  v_fma_f32 v24, v24, s98, v60
  v_fma_f32 v45, -v25, s98, v61
  v_fma_f32 v25, v25, s98, v60
  v_fma_f32 v46, -v26, s98, v61
  v_fma_f32 v26, v26, s98, v60
  v_fma_f32 v47, -v27, s98, v61
  v_fma_f32 v27, v27, s98, v60
  v_fma_f32 v48, -v28, s98, v61
  v_fma_f32 v28, v28, s98, v60
  v_fma_f32 v49, -v29, s98, v61
  v_fma_f32 v29, v29, s98, v60
  v_fma_f32 v50, -v30, s98, v61
  v_fma_f32 v30, v30, s98, v60
  v_fma_f32 v51, -v31, s98, v61
  v_fma_f32 v31, v31, s98, v60
  v_fma_f32 v52, -v32, s98, v61
  v_fma_f32 v32, v32, s98, v60
  v_fma_f32 v53, -v33, s98, v61
  v_fma_f32 v33, v33, s98, v60
  v_fma_f32 v54, -v34, s98, v61
  v_fma_f32 v34, v34, s98, v60
  v_fma_f32 v55, -v35, s98, v61
  v_fma_f32 v35, v35, s98, v60
  v_fma_f32 v56, -v36, s98, v61
  v_fma_f32 v36, v36, s98, v60
  v_fma_f32 v57, -v37, s98, v61
  v_fma_f32 v37, v37, s98, v60
  v_fma_f32 v58, -v38, s98, v61
  v_fma_f32 v38, v38, s98, v60
  v_fma_f32 v59, -v39, s98, v61
  v_fma_f32 v39, v39, s98, v60
  v_exp_f32 v20, v20
  v_exp_f32 v40, v40
  v_exp_f32 v21, v21
  v_exp_f32 v41, v41
  v_exp_f32 v22, v22
  v_exp_f32 v42, v42
  v_exp_f32 v23, v23
  v_exp_f32 v43, v43
  v_exp_f32 v24, v24
  v_exp_f32 v44, v44
  v_exp_f32 v25, v25
  v_exp_f32 v45, v45
  v_exp_f32 v26, v26
  v_exp_f32 v46, v46
  v_exp_f32 v27, v27
  v_exp_f32 v47, v47
  v_exp_f32 v28, v28
  v_exp_f32 v48, v48
  v_exp_f32 v29, v29
  v_exp_f32 v49, v49
  v_exp_f32 v30, v30
  v_exp_f32 v50, v50
  v_exp_f32 v31, v31
  v_exp_f32 v51, v51
  v_exp_f32 v32, v32
  v_exp_f32 v52, v52
  v_exp_f32 v33, v33
  v_exp_f32 v53, v53
  v_exp_f32 v34, v34
  v_exp_f32 v54, v54
  v_exp_f32 v35, v35
  v_exp_f32 v55, v55
  v_exp_f32 v36, v36
  v_exp_f32 v56, v56
  v_exp_f32 v37, v37
  v_exp_f32 v57, v57
  v_exp_f32 v38, v38
  v_exp_f32 v58, v58
  v_exp_f32 v39, v39
  v_exp_f32 v59, v59
  v_pk_add_f32 v[62:63], v[20:21], v[22:23]
  v_pk_add_f32 v[64:65], v[40:41], v[42:43]
  v_pk_add_f32 v[62:63], v[62:63], v[24:25]
  v_pk_add_f32 v[64:65], v[64:65], v[44:45]
  v_pk_add_f32 v[62:63], v[62:63], v[26:27]
  v_pk_add_f32 v[64:65], v[64:65], v[46:47]
  v_pk_add_f32 v[62:63], v[62:63], v[28:29]
  v_pk_add_f32 v[64:65], v[64:65], v[48:49]
  v_pk_add_f32 v[62:63], v[62:63], v[30:31]
  v_pk_add_f32 v[64:65], v[64:65], v[50:51]
  v_pk_add_f32 v[62:63], v[62:63], v[32:33]
  v_pk_add_f32 v[64:65], v[64:65], v[52:53]
  v_pk_add_f32 v[62:63], v[62:63], v[34:35]
  v_pk_add_f32 v[64:65], v[64:65], v[54:55]
  v_pk_add_f32 v[62:63], v[62:63], v[36:37]
  v_pk_add_f32 v[64:65], v[64:65], v[56:57]
  v_pk_add_f32 v[62:63], v[62:63], v[38:39]
  v_pk_add_f32 v[64:65], v[64:65], v[58:59]
  v_add_f32 v62, v62, v63
  v_add_f32 v64, v64, v65
  v_rcp_f32 v62, v62
  v_rcp_f32 v64, v64
  s_nop 0
  v_pk_mul_f32 v[20:21], v[20:21], v[62:63] op_sel_hi:[1,0]
  v_pk_mul_f32 v[40:41], v[40:41], v[64:65] op_sel_hi:[1,0]
  v_pk_mul_f32 v[22:23], v[22:23], v[62:63] op_sel_hi:[1,0]
  v_pk_mul_f32 v[42:43], v[42:43], v[64:65] op_sel_hi:[1,0]
  v_pk_mul_f32 v[24:25], v[24:25], v[62:63] op_sel_hi:[1,0]
  v_pk_mul_f32 v[44:45], v[44:45], v[64:65] op_sel_hi:[1,0]
  v_pk_mul_f32 v[26:27], v[26:27], v[62:63] op_sel_hi:[1,0]
  v_pk_mul_f32 v[46:47], v[46:47], v[64:65] op_sel_hi:[1,0]
  v_pk_mul_f32 v[28:29], v[28:29], v[62:63] op_sel_hi:[1,0]
  v_pk_mul_f32 v[48:49], v[48:49], v[64:65] op_sel_hi:[1,0]
  v_pk_mul_f32 v[30:31], v[30:31], v[62:63] op_sel_hi:[1,0]
  v_pk_mul_f32 v[50:51], v[50:51], v[64:65] op_sel_hi:[1,0]
  v_pk_mul_f32 v[32:33], v[32:33], v[62:63] op_sel_hi:[1,0]
  v_pk_mul_f32 v[52:53], v[52:53], v[64:65] op_sel_hi:[1,0]
  v_pk_mul_f32 v[34:35], v[34:35], v[62:63] op_sel_hi:[1,0]
  v_pk_mul_f32 v[54:55], v[54:55], v[64:65] op_sel_hi:[1,0]
  v_pk_mul_f32 v[36:37], v[36:37], v[62:63] op_sel_hi:[1,0]
  v_pk_mul_f32 v[56:57], v[56:57], v[64:65] op_sel_hi:[1,0]
  v_pk_mul_f32 v[38:39], v[38:39], v[62:63] op_sel_hi:[1,0]
  v_pk_mul_f32 v[58:59], v[58:59], v[64:65] op_sel_hi:[1,0]
  v_cvt_pk_bf16_f32 v68, v20, v21
  v_cvt_pk_bf16_f32 v69, v22, v23
  v_cvt_pk_bf16_f32 v70, v24, v25
  v_cvt_pk_bf16_f32 v71, v26, v27
  v_cvt_pk_bf16_f32 v72, v28, v29
  v_cvt_pk_bf16_f32 v73, v30, v31
  v_cvt_pk_bf16_f32 v74, v32, v33
  v_cvt_pk_bf16_f32 v75, v34, v35
  v_cvt_pk_bf16_f32 v76, v36, v37
  v_cvt_pk_bf16_f32 v77, v38, v39
  v_cvt_pk_bf16_f32 v78, v40, v41
  v_cvt_pk_bf16_f32 v79, v42, v43
  v_cvt_pk_bf16_f32 v80, v44, v45
  v_cvt_pk_bf16_f32 v81, v46, v47
  v_cvt_pk_bf16_f32 v82, v48, v49
  v_cvt_pk_bf16_f32 v83, v50, v51
  v_cvt_pk_bf16_f32 v84, v52, v53
  v_cvt_pk_bf16_f32 v85, v54, v55
  v_cvt_pk_bf16_f32 v86, v56, v57
  v_cvt_pk_bf16_f32 v87, v58, v59
  s_mov_b32 s30, 0
  s_mov_b64 exec, 1
concat_heads__grouped_kv_mqa__linear_kernel_hedgehog__prompt_kernel_poll:
  buffer_load_dword v4, v5, s[8:11], 0 offen sc0 sc1
  s_waitcnt vmcnt(0)
  v_readfirstlane_b32 s31, v4
  s_add_u32 s30, s30, 1
  s_cmp_ge_u32 s31, 32
  s_cbranch_scc1 concat_heads__grouped_kv_mqa__linear_kernel_hedgehog__prompt_kernel_pdone
  s_cmp_gt_u32 s30, 2000000
  s_cbranch_scc1 concat_heads__grouped_kv_mqa__linear_kernel_hedgehog__prompt_kernel_pdone
  s_sleep 8
  s_branch concat_heads__grouped_kv_mqa__linear_kernel_hedgehog__prompt_kernel_poll
concat_heads__grouped_kv_mqa__linear_kernel_hedgehog__prompt_kernel_pdone:
  s_mov_b64 exec, -1
  s_mul_i32 s28, s26, 7680
  s_lshl_b32 s29, s3, 11
  s_add_u32 s28, s28, s29
  s_add_u32 s28, s28, 18874368
  buffer_load_dwordx4 v[8:11], v120, s[8:11], s28 offen sc0 sc1
  buffer_load_dwordx4 v[12:15], v120, s[8:11], s28 offen offset:1024 sc0 sc1
  s_add_u32 s29, s29, 126976
  v_add_u32 v4, s29, v120
  s_waitcnt vmcnt(0)
  ds_write_b128 v4, v[8:11]
  s_cmp_eq_u32 s3, 3
  s_cselect_b32 s30, -1, -1
  s_cselect_b32 s31, 0, -1
  s_mov_b64 exec, s[30:31]
  ds_write_b128 v4, v[12:15] offset:1024
  s_mov_b64 exec, -1
  s_waitcnt lgkmcnt(0)
  s_barrier
  s_mov_b32 m0, s21
  s_nop 0
  buffer_load_dwordx4 v120, s[8:11], s20 offen offset:0 lds
  buffer_load_dwordx4 v120, s[8:11], s20 offen offset:1024 lds
  buffer_load_dwordx4 v120, s[8:11], s20 offen offset:2048 lds
  s_mov_b64 exec, s[38:39]
  buffer_load_dwordx4 v120, s[8:11], s20 offen offset:3072 lds
  s_mov_b64 exec, -1
  s_add_u32 s20, s20, 3584
  s_add_u32 s21, s21, 3584
  s_mov_b32 m0, s21
  s_nop 0
  buffer_load_dwordx4 v120, s[8:11], s20 offen offset:0 lds
  buffer_load_dwordx4 v120, s[8:11], s20 offen offset:1024 lds
  buffer_load_dwordx4 v120, s[8:11], s20 offen offset:2048 lds
  s_mov_b64 exec, s[38:39]
  buffer_load_dwordx4 v120, s[8:11], s20 offen offset:3072 lds
  s_mov_b64 exec, -1
  s_add_u32 s20, s20, 3584
  s_add_u32 s21, s21, 3584
  v_lshrrev_b32 v3, 4, v2
  v_and_b32 v4, 3, v2
  v_cmp_eq_u32 vcc, v3, v4
  v_mul_u32_u24 v3, 1920, v3
  v_bfe_u32 v4, v2, 2, 2
  v_mul_u32_u24 v4, 48, v4
  v_add_u32 v3, v3, v4
  v_add_u32 v3, 126976, v3
  v_mov_b32 v4, 134656
  v_cndmask_b32 v3, v4, v3, vcc
  ds_read_b64_tr_b16 v[32:33], v3 offset:0
  ds_read_b64_tr_b16 v[34:35], v3 offset:192
  ds_read_b64_tr_b16 v[36:37], v3 offset:8
  ds_read_b64_tr_b16 v[38:39], v3 offset:200
  ds_read_b64_tr_b16 v[40:41], v3 offset:16
  ds_read_b64_tr_b16 v[42:43], v3 offset:208
  ds_read_b64_tr_b16 v[44:45], v3 offset:24
  ds_read_b64_tr_b16 v[46:47], v3 offset:216
  ds_read_b64_tr_b16 v[48:49], v3 offset:32
  ds_read_b64_tr_b16 v[50:51], v3 offset:224
  ds_read_b64_tr_b16 v[52:53], v3 offset:40
  ds_read_b64_tr_b16 v[54:55], v3 offset:232
  ds_read_b64_tr_b16 v[88:89], v3 offset:384
  ds_read_b64_tr_b16 v[90:91], v3 offset:576
  ds_read_b64_tr_b16 v[92:93], v3 offset:392
  ds_read_b64_tr_b16 v[94:95], v3 offset:584
  ds_read_b64_tr_b16 v[96:97], v3 offset:400
  ds_read_b64_tr_b16 v[98:99], v3 offset:592
  ds_read_b64_tr_b16 v[100:101], v3 offset:408
  ds_read_b64_tr_b16 v[102:103], v3 offset:600
  ds_read_b64_tr_b16 v[104:105], v3 offset:416
  ds_read_b64_tr_b16 v[106:107], v3 offset:608
  ds_read_b64_tr_b16 v[108:109], v3 offset:424
  ds_read_b64_tr_b16 v[110:111], v3 offset:616
  s_waitcnt lgkmcnt(12)
  v_mfma_f32_16x16x32_bf16 v[8:11], v[32:35], v[68:71], 0
  v_mfma_f32_16x16x32_bf16 v[12:15], v[36:39], v[68:71], 0
  v_mfma_f32_16x16x32_bf16 v[16:19], v[40:43], v[68:71], 0
  v_mfma_f32_16x16x32_bf16 v[20:23], v[44:47], v[68:71], 0
  v_mfma_f32_16x16x32_bf16 v[24:27], v[48:51], v[68:71], 0
  v_mfma_f32_16x16x32_bf16 v[28:31], v[52:55], v[68:71], 0
  s_nop 3
  ds_read_b64_tr_b16 v[32:33], v3 offset:768
  ds_read_b64_tr_b16 v[34:35], v3 offset:960
  ds_read_b64_tr_b16 v[36:37], v3 offset:776
  ds_read_b64_tr_b16 v[38:39], v3 offset:968
  ds_read_b64_tr_b16 v[40:41], v3 offset:784
  ds_read_b64_tr_b16 v[42:43], v3 offset:976
  ds_read_b64_tr_b16 v[44:45], v3 offset:792
  ds_read_b64_tr_b16 v[46:47], v3 offset:984
  ds_read_b64_tr_b16 v[48:49], v3 offset:800
  ds_read_b64_tr_b16 v[50:51], v3 offset:992
  ds_read_b64_tr_b16 v[52:53], v3 offset:808
  ds_read_b64_tr_b16 v[54:55], v3 offset:1000
  s_waitcnt lgkmcnt(12)
  v_mfma_f32_16x16x32_bf16 v[8:11], v[88:91], v[72:75], v[8:11]
  v_mfma_f32_16x16x32_bf16 v[12:15], v[92:95], v[72:75], v[12:15]
  v_mfma_f32_16x16x32_bf16 v[16:19], v[96:99], v[72:75], v[16:19]
  v_mfma_f32_16x16x32_bf16 v[20:23], v[100:103], v[72:75], v[20:23]
  v_mfma_f32_16x16x32_bf16 v[24:27], v[104:107], v[72:75], v[24:27]
  v_mfma_f32_16x16x32_bf16 v[28:31], v[108:111], v[72:75], v[28:31]
  s_nop 3
  ds_read_b64_tr_b16 v[88:89], v3 offset:1152
  ds_read_b64_tr_b16 v[90:91], v3 offset:1344
  ds_read_b64_tr_b16 v[92:93], v3 offset:1160
  ds_read_b64_tr_b16 v[94:95], v3 offset:1352
  ds_read_b64_tr_b16 v[96:97], v3 offset:1168
  ds_read_b64_tr_b16 v[98:99], v3 offset:1360
  ds_read_b64_tr_b16 v[100:101], v3 offset:1176
  ds_read_b64_tr_b16 v[102:103], v3 offset:1368
  ds_read_b64_tr_b16 v[104:105], v3 offset:1184
  ds_read_b64_tr_b16 v[106:107], v3 offset:1376
  ds_read_b64_tr_b16 v[108:109], v3 offset:1192
  ds_read_b64_tr_b16 v[110:111], v3 offset:1384
  s_waitcnt lgkmcnt(12)
  v_mfma_f32_16x16x32_bf16 v[8:11], v[32:35], v[76:79], v[8:11]
  v_mfma_f32_16x16x32_bf16 v[12:15], v[36:39], v[76:79], v[12:15]
  v_mfma_f32_16x16x32_bf16 v[16:19], v[40:43], v[76:79], v[16:19]
  v_mfma_f32_16x16x32_bf16 v[20:23], v[44:47], v[76:79], v[20:23]
  v_mfma_f32_16x16x32_bf16 v[24:27], v[48:51], v[76:79], v[24:27]
  v_mfma_f32_16x16x32_bf16 v[28:31], v[52:55], v[76:79], v[28:31]
  s_nop 3
  ds_read_b64_tr_b16 v[32:33], v3 offset:1536
  ds_read_b64_tr_b16 v[34:35], v3 offset:1728
  ds_read_b64_tr_b16 v[36:37], v3 offset:1544
  ds_read_b64_tr_b16 v[38:39], v3 offset:1736
  ds_read_b64_tr_b16 v[40:41], v3 offset:1552
  ds_read_b64_tr_b16 v[42:43], v3 offset:1744
  ds_read_b64_tr_b16 v[44:45], v3 offset:1560
  ds_read_b64_tr_b16 v[46:47], v3 offset:1752
  ds_read_b64_tr_b16 v[48:49], v3 offset:1568
  ds_read_b64_tr_b16 v[50:51], v3 offset:1760
  ds_read_b64_tr_b16 v[52:53], v3 offset:1576
  ds_read_b64_tr_b16 v[54:55], v3 offset:1768
  s_waitcnt lgkmcnt(12)
  v_mfma_f32_16x16x32_bf16 v[8:11], v[88:91], v[80:83], v[8:11]
  v_mfma_f32_16x16x32_bf16 v[12:15], v[92:95], v[80:83], v[12:15]
  v_mfma_f32_16x16x32_bf16 v[16:19], v[96:99], v[80:83], v[16:19]
  v_mfma_f32_16x16x32_bf16 v[20:23], v[100:103], v[80:83], v[20:23]
  v_mfma_f32_16x16x32_bf16 v[24:27], v[104:107], v[80:83], v[24:27]
  v_mfma_f32_16x16x32_bf16 v[28:31], v[108:111], v[80:83], v[28:31]
  s_nop 3
  s_waitcnt lgkmcnt(0)
  v_mfma_f32_16x16x32_bf16 v[8:11], v[32:35], v[84:87], v[8:11]
  v_mfma_f32_16x16x32_bf16 v[12:15], v[36:39], v[84:87], v[12:15]
  v_mfma_f32_16x16x32_bf16 v[16:19], v[40:43], v[84:87], v[16:19]
  v_mfma_f32_16x16x32_bf16 v[20:23], v[44:47], v[84:87], v[20:23]
  v_mfma_f32_16x16x32_bf16 v[24:27], v[48:51], v[84:87], v[24:27]
  v_mfma_f32_16x16x32_bf16 v[28:31], v[52:55], v[84:87], v[28:31]
  s_nop 3
  s_nop 7
  v_add_f32 v28, 0x358637bd, v28
  v_rcp_f32 v28, v28
  s_nop 0
  v_mul_f32 v8, v8, v28
  v_mul_f32 v9, v9, v28
  v_mul_f32 v10, v10, v28
  v_mul_f32 v11, v11, v28
  v_mul_f32 v12, v12, v28
  v_mul_f32 v13, v13, v28
  v_mul_f32 v14, v14, v28
  v_mul_f32 v15, v15, v28
  v_mul_f32 v16, v16, v28
  v_mul_f32 v17, v17, v28
  v_mul_f32 v18, v18, v28
  v_mul_f32 v19, v19, v28
  v_mul_f32 v20, v20, v28
  v_mul_f32 v21, v21, v28
  v_mul_f32 v22, v22, v28
  v_mul_f32 v23, v23, v28
  v_mul_f32 v24, v24, v28
  v_mul_f32 v25, v25, v28
  v_mul_f32 v26, v26, v28
  v_mul_f32 v27, v27, v28
  v_cvt_pk_bf16_f32 v40, v8, v9
  v_cvt_pk_bf16_f32 v41, v10, v11
  v_cvt_pk_bf16_f32 v42, v12, v13
  v_cvt_pk_bf16_f32 v43, v14, v15
  v_cvt_pk_bf16_f32 v44, v16, v17
  v_cvt_pk_bf16_f32 v45, v18, v19
  v_cvt_pk_bf16_f32 v46, v20, v21
  v_cvt_pk_bf16_f32 v47, v22, v23
  v_cvt_pk_bf16_f32 v48, v24, v25
  v_cvt_pk_bf16_f32 v49, v26, v27
  v_and_b32 v3, 15, v2
  v_mul_u32_u24 v3, 160, v3
  v_lshrrev_b32 v4, 4, v2
  v_mul_u32_u24 v4, 40, v4
  v_add_u32 v3, v3, v4
  s_mul_i32 s29, s3, 2560
  s_add_u32 s29, s29, 136704
  v_add_u32 v3, s29, v3
  ds_write_b64 v3, v[40:41] offset:0
  ds_write_b64 v3, v[42:43] offset:8
  ds_write_b64 v3, v[44:45] offset:16
  ds_write_b64 v3, v[46:47] offset:24
  ds_write_b64 v3, v[48:49] offset:32
  s_lshl_b32 s28, s27, 6
  s_lshl_b32 s30, s3, 4
  s_add_u32 s28, s28, s30
  s_mul_i32 s28, s28, 1280
  s_mul_i32 s30, s26, 160
  s_add_u32 s28, s28, s30
  s_add_u32 s28, s28, 7340032
  v_add_u32 v52, 0, v2
  v_mul_u32_u24 v53, 6554, v52
  v_lshrrev_b32 v53, 16, v53
  v_mul_u32_u24 v54, 10, v53
  v_sub_u32 v54, v52, v54
  v_mul_u32_u24 v53, 1280, v53
  v_lshl_add_u32 v53, v54, 4, v53
  v_cmp_gt_u32 vcc, 160, v52
  v_mov_b32 v4, 0x7f000000
  v_lshlrev_b32 v52, 4, v52
  v_cndmask_b32 v53, v4, v53, vcc
  v_add_u32 v52, s29, v52
  v_add_u32 v55, 64, v2
  v_mul_u32_u24 v56, 6554, v55
  v_lshrrev_b32 v56, 16, v56
  v_mul_u32_u24 v57, 10, v56
  v_sub_u32 v57, v55, v57
  v_mul_u32_u24 v56, 1280, v56
  v_lshl_add_u32 v56, v57, 4, v56
  v_cmp_gt_u32 vcc, 160, v55
  v_mov_b32 v4, 0x7f000000
  v_lshlrev_b32 v55, 4, v55
  v_cndmask_b32 v56, v4, v56, vcc
  v_add_u32 v55, s29, v55
  v_add_u32 v58, 128, v2
  v_mul_u32_u24 v59, 6554, v58
  v_lshrrev_b32 v59, 16, v59
  v_mul_u32_u24 v60, 10, v59
  v_sub_u32 v60, v58, v60
  v_mul_u32_u24 v59, 1280, v59
  v_lshl_add_u32 v59, v60, 4, v59
  v_cmp_gt_u32 vcc, 160, v58
  v_mov_b32 v4, 0x7f000000
  v_lshlrev_b32 v58, 4, v58
  v_cndmask_b32 v59, v4, v59, vcc
  v_add_u32 v58, s29, v58
  s_waitcnt lgkmcnt(0)
  ds_read_b128 v[64:67], v52
  ds_read_b128 v[68:71], v55
  ds_read_b128 v[72:75], v58
  s_waitcnt lgkmcnt(0)
  buffer_store_dwordx4 v[64:67], v53, s[8:11], s28 offen sc0 sc1
  buffer_store_dwordx4 v[68:71], v56, s[8:11], s28 offen sc0 sc1
  buffer_store_dwordx4 v[72:75], v59, s[8:11], s28 offen sc0 sc1
  s_waitcnt vmcnt(3)
  s_barrier
  s_waitcnt vmcnt(0)
  s_lshr_b32 s29, s2, 4
  s_lshl_b32 s29, s29, 7
  s_add_u32 s29, s29, 19926016
  v_mov_b32 v5, s29
  s_mov_b64 exec, 1
  v_mov_b32 v4, 1
  buffer_atomic_add v4, v5, s[8:11], 0 offen sc1
  s_mov_b64 exec, -1
  s_and_b32 s26, s2, 1
  s_lshr_b32 s27, s2, 1
  s_and_b32 s27, s27, 7
  s_lshr_b32 s28, s2, 4
  s_cmp_eq_u32 s26, 0
  s_cselect_b32 s48, s92, s94
  s_cselect_b32 s49, s93, s95
  s_and_b32 s49, s49, 0xffff
  s_mov_b32 s50, 819200
  s_mov_b32 s51, 0x20000
  s_mul_i32 s28, s28, 400
  s_mul_i32 s29, s3, 100
  s_add_u32 s28, s28, s29
  s_mul_i32 s29, s27, 160
  s_lshl_b32 s30, s26, 3
  s_add_u32 s30, s30, s27
  s_mul_i32 s30, s30, 102400
  s_add_u32 s30, s30, 20971520
  v_add_u32 v8, s28, v2
  v_mul_u32_u24 v9, 6554, v8
  v_lshrrev_b32 v9, 16, v9
  v_mul_u32_u24 v10, 10, v9
  v_sub_u32 v10, v8, v10
  v_and_b32 v11, 0xfffffff3, v9
  v_and_b32 v12, 4, v9
  v_lshlrev_b32 v12, 1, v12
  v_and_b32 v13, 8, v9
  v_lshrrev_b32 v13, 1, v13
  v_or3_b32 v11, v11, v12, v13
  v_mul_u32_u24 v11, 1280, v11
  v_lshl_add_u32 v11, v10, 4, v11
  v_lshlrev_b32 v8, 4, v8
  buffer_load_dwordx4 v[24:27], v11, s[48:51], s29 offen
  v_add_u32 v16, s28, v2
  v_add_u32 v16, 64, v16
  v_mul_u32_u24 v17, 6554, v16
  v_lshrrev_b32 v17, 16, v17
  v_mul_u32_u24 v18, 10, v17
  v_sub_u32 v18, v16, v18
  v_and_b32 v19, 0xfffffff3, v17
  v_and_b32 v20, 4, v17
  v_lshlrev_b32 v20, 1, v20
  v_and_b32 v21, 8, v17
  v_lshrrev_b32 v21, 1, v21
  v_or3_b32 v19, v19, v20, v21
  v_mul_u32_u24 v19, 1280, v19
  v_lshl_add_u32 v19, v18, 4, v19
  v_lshlrev_b32 v16, 4, v16
  v_cmp_gt_u32 vcc, 36, v2
  v_mov_b32 v7, 0x7f000000
  s_nop 0
  v_cndmask_b32 v19, v7, v19, vcc
  v_cndmask_b32 v16, v7, v16, vcc
  buffer_load_dwordx4 v[28:31], v19, s[48:51], s29 offen
  s_waitcnt vmcnt(0)
  buffer_store_dwordx4 v[24:27], v8, s[8:11], s30 offen sc0 sc1
  buffer_store_dwordx4 v[28:31], v16, s[8:11], s30 offen sc0 sc1
  s_waitcnt vmcnt(0)
  s_lshl_b32 s30, s26, 3
  s_add_u32 s30, s30, s27
  s_lshl_b32 s30, s30, 7
  s_add_u32 s30, s30, 19928064
  v_mov_b32 v5, s30
  s_mov_b64 exec, 1
  v_mov_b32 v4, 1
  buffer_atomic_add v4, v5, s[8:11], 0 offen sc1
  s_mov_b64 exec, -1
concat_heads__grouped_kv_mqa__linear_kernel_hedgehog__prompt_kernel_he1:
  s_barrier
  s_barrier
  v_mov_b32 v4, 124928
  ds_read_b128 v[8:11], v4
  s_waitcnt lgkmcnt(0)
  v_or3_b32 v8, v8, v9, v10
  v_or_b32 v8, v8, v11
  s_nop 1
  v_readfirstlane_b32 s26, v8
  s_cmp_eq_u32 s26, 0
  s_cbranch_scc1 concat_heads__grouped_kv_mqa__linear_kernel_hedgehog__prompt_kernel_hf2
  s_barrier
  s_branch concat_heads__grouped_kv_mqa__linear_kernel_hedgehog__prompt_kernel_he1
concat_heads__grouped_kv_mqa__linear_kernel_hedgehog__prompt_kernel_hf2:
  s_barrier
  s_setprio 0
  s_sub_u32 s3, s100, 4
  s_cmp_lg_u32 s3, 0
  s_cbranch_scc1 concat_heads__grouped_kv_mqa__linear_kernel_hedgehog__prompt_kernel_l0a
  s_lshr_b32 s29, s2, 4
  s_lshl_b32 s29, s29, 7
  s_add_u32 s29, s29, 19923968
  v_mov_b32 v5, s29
  s_mov_b64 exec, 1
  v_mov_b32 v4, 1
  buffer_atomic_add v4, v5, s[8:11], 0 offen sc1
  s_mov_b64 exec, -1
concat_heads__grouped_kv_mqa__linear_kernel_hedgehog__prompt_kernel_l0a:
  s_and_b32 s40, s2, 1
  s_lshr_b32 s41, s2, 1
  s_and_b32 s41, s41, 3
  s_lshl_b32 s41, s41, 2
  s_lshr_b32 s42, s2, 3
  s_and_b32 s43, s42, 3
  s_add_u32 s41, s41, s43
  s_lshr_b32 s42, s42, 2
  s_movk_i32 s44, 1280
  v_lshrrev_b32 v32, 3, v1
  v_and_b32 v33, 7, v1
  v_xor_b32 v33, v33, v32
  v_lshlrev_b32 v33, 4, v33
  v_mul_u32_u24 v32, 1280, v32
  v_add_u32 v16, v32, v33
  v_add_u32 v17, 10240, v16
  v_add_u32 v18, 20480, v16
  v_add_u32 v19, 30720, v16
  v_add_u32 v20, 40960, v16
  v_add_u32 v21, 51200, v16
  v_add_u32 v22, 61440, v16
  v_add_u32 v23, 71680, v16
  v_lshlrev_b32 v24, 4, v1
  v_add_u32 v25, 4096, v24
  s_lshr_b32 s45, s3, 1
  s_and_b32 s46, s3, 1
  s_lshl_b32 s20, s41, 7
  s_lshl_b32 s49, s46, 6
  s_add_u32 s20, s20, s49
  s_mul_i32 s20, s20, 1280
  s_mul_i32 s49, s45, 640
  s_add_u32 s20, s20, s49
  s_mov_b32 s49, 7340032
  s_cmp_eq_u32 s40, 0
  s_cselect_b32 s49, 4194304, s49
  s_add_u32 s20, s20, s49
  s_mul_i32 s21, s45, 320
  s_lshl_b32 s49, s46, 5
  s_add_u32 s21, s21, s49
  s_mul_i32 s21, s21, 160
  s_lshl_b32 s49, s40, 3
  s_add_u32 s49, s49, s42
  s_mul_i32 s49, s49, 102400
  s_add_u32 s21, s21, s49
  s_add_u32 s21, s21, 20971520
  s_mov_b32 s22, 10240
  s_lshl_b32 s24, s45, 14
  s_lshl_b32 s49, s46, 13
  s_add_u32 s24, s24, s49
  s_mul_i32 s25, s45, 10240
  s_mul_i32 s49, s46, 5120
  s_add_u32 s25, s25, s49
  s_add_u32 s25, s25, 32768
  s_add_u32 s23, s42, s43
  s_mul_i32 s49, s23, 52
  s_lshr_b32 s49, s49, 8
  s_mul_i32 s49, s49, 5
  s_sub_u32 s23, s23, s49
  s_mov_b32 s12, s4
  s_and_b32 s13, s5, 0xffff
  s_mov_b32 s14, 268435456
  s_mov_b32 s15, 0x00020000
  s_lshl_b32 s30, s40, 3
  s_add_u32 s30, s30, s42
  s_lshl_b32 s30, s30, 7
  s_add_u32 s30, s30, 19928064
  v_mov_b32 v5, s30
  s_mov_b32 s30, 0
  s_mov_b64 exec, 1
concat_heads__grouped_kv_mqa__linear_kernel_hedgehog__prompt_kernel_pw:
  buffer_load_dword v4, v5, s[8:11], 0 offen sc1
  s_waitcnt vmcnt(0)
  v_readfirstlane_b32 s31, v4
  s_add_u32 s30, s30, 1
  s_cmp_ge_u32 s31, 64
  s_cbranch_scc1 concat_heads__grouped_kv_mqa__linear_kernel_hedgehog__prompt_kernel_pw_d
  s_cmp_gt_u32 s30, 1000000
  s_cbranch_scc1 concat_heads__grouped_kv_mqa__linear_kernel_hedgehog__prompt_kernel_pw_d
  s_sleep 1
  s_branch concat_heads__grouped_kv_mqa__linear_kernel_hedgehog__prompt_kernel_pw
concat_heads__grouped_kv_mqa__linear_kernel_hedgehog__prompt_kernel_pw_d:
  s_mov_b64 exec, -1
  s_add_u32 s27, s23, 0
  s_cmp_ge_u32 s27, 5
  s_cselect_b32 s49, 5, 0
  s_sub_u32 s27, s27, s49
  s_mul_i32 s29, s27, s22
  s_add_u32 s29, s29, s21
  s_add_u32 s31, s25, 0
  s_mov_b32 m0, s31
  s_nop 0
  buffer_load_dwordx4 v24, s[12:15], s29 offen offset:0 lds
  buffer_load_dwordx4 v24, s[12:15], s29 offen offset:1024 lds
  buffer_load_dwordx4 v24, s[12:15], s29 offen offset:2048 lds
  buffer_load_dwordx4 v24, s[12:15], s29 offen offset:3072 lds
  s_add_u32 m0, m0, 4096
  s_nop 0
  buffer_load_dwordx4 v25, s[12:15], s29 offen lds
  s_add_u32 s27, s23, 1
  s_cmp_ge_u32 s27, 5
  s_cselect_b32 s49, 5, 0
  s_sub_u32 s27, s27, s49
  s_mul_i32 s29, s27, s22
  s_add_u32 s29, s29, s21
  s_add_u32 s31, s25, 53248
  s_mov_b32 m0, s31
  s_nop 0
  buffer_load_dwordx4 v24, s[12:15], s29 offen offset:0 lds
  buffer_load_dwordx4 v24, s[12:15], s29 offen offset:1024 lds
  buffer_load_dwordx4 v24, s[12:15], s29 offen offset:2048 lds
  buffer_load_dwordx4 v24, s[12:15], s29 offen offset:3072 lds
  s_add_u32 m0, m0, 4096
  s_nop 0
  buffer_load_dwordx4 v25, s[12:15], s29 offen lds
  s_add_u32 s27, s23, 2
  s_cmp_ge_u32 s27, 5
  s_cselect_b32 s49, 5, 0
  s_sub_u32 s27, s27, s49
  s_mul_i32 s29, s27, s22
  s_add_u32 s29, s29, s21
  s_add_u32 s31, s25, 106496
  s_mov_b32 m0, s31
  s_nop 0
  buffer_load_dwordx4 v24, s[12:15], s29 offen offset:0 lds
  buffer_load_dwordx4 v24, s[12:15], s29 offen offset:1024 lds
  buffer_load_dwordx4 v24, s[12:15], s29 offen offset:2048 lds
  buffer_load_dwordx4 v24, s[12:15], s29 offen offset:3072 lds
  s_add_u32 m0, m0, 4096
  s_nop 0
  buffer_load_dwordx4 v25, s[12:15], s29 offen lds
  s_cmp_lg_u32 s3, 0
  s_cbranch_scc1 concat_heads__grouped_kv_mqa__linear_kernel_hedgehog__prompt_kernel_l0b
  s_mov_b32 s29, 19926016
  s_cmp_eq_u32 s40, 0
  s_cselect_b32 s29, 19923968, s29
  s_lshl_b32 s49, s41, 7
  s_add_u32 s29, s29, s49
  v_mov_b32 v5, s29
  s_cmp_eq_u32 s40, 0
  s_cbranch_scc0 concat_heads__grouped_kv_mqa__linear_kernel_hedgehog__prompt_kernel_l0c
  s_mov_b32 s30, 0
  s_mov_b64 exec, 1
concat_heads__grouped_kv_mqa__linear_kernel_hedgehog__prompt_kernel_po:
  buffer_load_dword v4, v5, s[8:11], 0 offen sc1
  s_waitcnt vmcnt(0)
  v_readfirstlane_b32 s31, v4
  s_add_u32 s30, s30, 1
  s_cmp_ge_u32 s31, 16
  s_cbranch_scc1 concat_heads__grouped_kv_mqa__linear_kernel_hedgehog__prompt_kernel_po_d
  s_cmp_gt_u32 s30, 1000000
  s_cbranch_scc1 concat_heads__grouped_kv_mqa__linear_kernel_hedgehog__prompt_kernel_po_d
  s_sleep 1
  s_branch concat_heads__grouped_kv_mqa__linear_kernel_hedgehog__prompt_kernel_po
concat_heads__grouped_kv_mqa__linear_kernel_hedgehog__prompt_kernel_po_d:
  s_mov_b64 exec, -1
  s_branch concat_heads__grouped_kv_mqa__linear_kernel_hedgehog__prompt_kernel_l0b
concat_heads__grouped_kv_mqa__linear_kernel_hedgehog__prompt_kernel_l0c:
  s_mov_b32 s30, 0
  s_mov_b64 exec, 1
concat_heads__grouped_kv_mqa__linear_kernel_hedgehog__prompt_kernel_pp:
  buffer_load_dword v4, v5, s[8:11], 0 offen sc1
  s_waitcnt vmcnt(0)
  v_readfirstlane_b32 s31, v4
  s_add_u32 s30, s30, 1
  s_cmp_ge_u32 s31, 64
  s_cbranch_scc1 concat_heads__grouped_kv_mqa__linear_kernel_hedgehog__prompt_kernel_pp_d
  s_cmp_gt_u32 s30, 1000000
  s_cbranch_scc1 concat_heads__grouped_kv_mqa__linear_kernel_hedgehog__prompt_kernel_pp_d
  s_sleep 1
  s_branch concat_heads__grouped_kv_mqa__linear_kernel_hedgehog__prompt_kernel_pp
concat_heads__grouped_kv_mqa__linear_kernel_hedgehog__prompt_kernel_pp_d:
  s_mov_b64 exec, -1
concat_heads__grouped_kv_mqa__linear_kernel_hedgehog__prompt_kernel_l0b:
  s_barrier
  s_add_u32 s27, s23, 0
  s_cmp_ge_u32 s27, 5
  s_cselect_b32 s49, 5, 0
  s_sub_u32 s27, s27, s49
  s_lshl_b32 s28, s27, 7
  s_add_u32 s28, s28, s20
  s_add_u32 s31, s24, 0
  s_mov_b32 m0, s31
  s_nop 0
  buffer_load_dwordx4 v16, s[8:11], s28 offen lds
  s_add_u32 m0, m0, 1024
  s_nop 0
  buffer_load_dwordx4 v17, s[8:11], s28 offen lds
  s_add_u32 m0, m0, 1024
  s_nop 0
  buffer_load_dwordx4 v18, s[8:11], s28 offen lds
  s_add_u32 m0, m0, 1024
  s_nop 0
  buffer_load_dwordx4 v19, s[8:11], s28 offen lds
  s_add_u32 m0, m0, 1024
  s_nop 0
  buffer_load_dwordx4 v20, s[8:11], s28 offen lds
  s_add_u32 m0, m0, 1024
  s_nop 0
  buffer_load_dwordx4 v21, s[8:11], s28 offen lds
  s_add_u32 m0, m0, 1024
  s_nop 0
  buffer_load_dwordx4 v22, s[8:11], s28 offen lds
  s_add_u32 m0, m0, 1024
  s_nop 0
  buffer_load_dwordx4 v23, s[8:11], s28 offen lds
  s_waitcnt vmcnt(0)
  s_barrier
  s_add_u32 s27, s23, 1
  s_cmp_ge_u32 s27, 5
  s_cselect_b32 s49, 5, 0
  s_sub_u32 s27, s27, s49
  s_lshl_b32 s28, s27, 7
  s_add_u32 s28, s28, s20
  s_add_u32 s31, s24, 53248
  s_mov_b32 m0, s31
  s_nop 0
  buffer_load_dwordx4 v16, s[8:11], s28 offen lds
  s_add_u32 m0, m0, 1024
  s_nop 0
  buffer_load_dwordx4 v17, s[8:11], s28 offen lds
  s_add_u32 m0, m0, 1024
  s_nop 0
  buffer_load_dwordx4 v18, s[8:11], s28 offen lds
  s_add_u32 m0, m0, 1024
  s_nop 0
  buffer_load_dwordx4 v19, s[8:11], s28 offen lds
  s_add_u32 m0, m0, 1024
  s_nop 0
  buffer_load_dwordx4 v20, s[8:11], s28 offen lds
  s_add_u32 m0, m0, 1024
  s_nop 0
  buffer_load_dwordx4 v21, s[8:11], s28 offen lds
  s_add_u32 m0, m0, 1024
  s_nop 0
  buffer_load_dwordx4 v22, s[8:11], s28 offen lds
  s_add_u32 m0, m0, 1024
  s_nop 0
  buffer_load_dwordx4 v23, s[8:11], s28 offen lds
  s_add_u32 s27, s23, 2
  s_cmp_ge_u32 s27, 5
  s_cselect_b32 s49, 5, 0
  s_sub_u32 s27, s27, s49
  s_lshl_b32 s28, s27, 7
  s_add_u32 s28, s28, s20
  s_add_u32 s31, s24, 106496
  s_mov_b32 m0, s31
  s_nop 0
  buffer_load_dwordx4 v16, s[8:11], s28 offen lds
  s_add_u32 m0, m0, 1024
  s_nop 0
  buffer_load_dwordx4 v17, s[8:11], s28 offen lds
  s_add_u32 m0, m0, 1024
  s_nop 0
  buffer_load_dwordx4 v18, s[8:11], s28 offen lds
  s_add_u32 m0, m0, 1024
  s_nop 0
  buffer_load_dwordx4 v19, s[8:11], s28 offen lds
  s_add_u32 m0, m0, 1024
  s_nop 0
  buffer_load_dwordx4 v20, s[8:11], s28 offen lds
  s_add_u32 m0, m0, 1024
  s_nop 0
  buffer_load_dwordx4 v21, s[8:11], s28 offen lds
  s_add_u32 m0, m0, 1024
  s_nop 0
  buffer_load_dwordx4 v22, s[8:11], s28 offen lds
  s_add_u32 m0, m0, 1024
  s_nop 0
  buffer_load_dwordx4 v23, s[8:11], s28 offen lds
  s_waitcnt vmcnt(8)
  s_barrier
  s_add_u32 s27, s23, 3
  s_cmp_ge_u32 s27, 5
  s_cselect_b32 s49, 5, 0
  s_sub_u32 s27, s27, s49
  s_lshl_b32 s28, s27, 7
  s_add_u32 s28, s28, s20
  s_add_u32 s31, s24, 0
  s_mov_b32 m0, s31
  s_nop 0
  buffer_load_dwordx4 v16, s[8:11], s28 offen lds
  s_add_u32 m0, m0, 1024
  s_nop 0
  buffer_load_dwordx4 v17, s[8:11], s28 offen lds
  s_add_u32 m0, m0, 1024
  s_nop 0
  buffer_load_dwordx4 v18, s[8:11], s28 offen lds
  s_add_u32 m0, m0, 1024
  s_nop 0
  buffer_load_dwordx4 v19, s[8:11], s28 offen lds
  s_add_u32 m0, m0, 1024
  s_nop 0
  buffer_load_dwordx4 v20, s[8:11], s28 offen lds
  s_add_u32 m0, m0, 1024
  s_nop 0
  buffer_load_dwordx4 v21, s[8:11], s28 offen lds
  s_add_u32 m0, m0, 1024
  s_nop 0
  buffer_load_dwordx4 v22, s[8:11], s28 offen lds
  s_add_u32 m0, m0, 1024
  s_nop 0
  buffer_load_dwordx4 v23, s[8:11], s28 offen lds
  s_add_u32 s27, s23, 3
  s_cmp_ge_u32 s27, 5
  s_cselect_b32 s49, 5, 0
  s_sub_u32 s27, s27, s49
  s_mul_i32 s29, s27, s22
  s_add_u32 s29, s29, s21
  s_add_u32 s31, s25, 0
  s_mov_b32 m0, s31
  s_nop 0
  buffer_load_dwordx4 v24, s[12:15], s29 offen offset:0 lds
  buffer_load_dwordx4 v24, s[12:15], s29 offen offset:1024 lds
  buffer_load_dwordx4 v24, s[12:15], s29 offen offset:2048 lds
  buffer_load_dwordx4 v24, s[12:15], s29 offen offset:3072 lds
  s_add_u32 m0, m0, 4096
  s_nop 0
  buffer_load_dwordx4 v25, s[12:15], s29 offen lds
  s_waitcnt vmcnt(13)
  s_barrier
  s_add_u32 s27, s23, 4
  s_cmp_ge_u32 s27, 5
  s_cselect_b32 s49, 5, 0
  s_sub_u32 s27, s27, s49
  s_lshl_b32 s28, s27, 7
  s_add_u32 s28, s28, s20
  s_add_u32 s31, s24, 53248
  s_mov_b32 m0, s31
  s_nop 0
  buffer_load_dwordx4 v16, s[8:11], s28 offen lds
  s_add_u32 m0, m0, 1024
  s_nop 0
  buffer_load_dwordx4 v17, s[8:11], s28 offen lds
  s_add_u32 m0, m0, 1024
  s_nop 0
  buffer_load_dwordx4 v18, s[8:11], s28 offen lds
  s_add_u32 m0, m0, 1024
  s_nop 0
  buffer_load_dwordx4 v19, s[8:11], s28 offen lds
  s_add_u32 m0, m0, 1024
  s_nop 0
  buffer_load_dwordx4 v20, s[8:11], s28 offen lds
  s_add_u32 m0, m0, 1024
  s_nop 0
  buffer_load_dwordx4 v21, s[8:11], s28 offen lds
  s_add_u32 m0, m0, 1024
  s_nop 0
  buffer_load_dwordx4 v22, s[8:11], s28 offen lds
  s_add_u32 m0, m0, 1024
  s_nop 0
  buffer_load_dwordx4 v23, s[8:11], s28 offen lds
  s_add_u32 s27, s23, 4
  s_cmp_ge_u32 s27, 5
  s_cselect_b32 s49, 5, 0
  s_sub_u32 s27, s27, s49
  s_mul_i32 s29, s27, s22
  s_add_u32 s29, s29, s21
  s_add_u32 s31, s25, 53248
  s_mov_b32 m0, s31
  s_nop 0
  buffer_load_dwordx4 v24, s[12:15], s29 offen offset:0 lds
  buffer_load_dwordx4 v24, s[12:15], s29 offen offset:1024 lds
  buffer_load_dwordx4 v24, s[12:15], s29 offen offset:2048 lds
  buffer_load_dwordx4 v24, s[12:15], s29 offen offset:3072 lds
  s_add_u32 m0, m0, 4096
  s_nop 0
  buffer_load_dwordx4 v25, s[12:15], s29 offen lds
  s_waitcnt vmcnt(13)
  s_barrier
  s_waitcnt vmcnt(0)
  s_barrier
  s_barrier
  s_endpgm
concat_heads__grouped_kv_mqa__linear_kernel_hedgehog__prompt_kernel_compute:
  s_mov_b32 s3, s100
  s_lshr_b32 s49, s3, 1
  s_lshl_b32 s50, s49, 13
  s_and_b32 s49, s3, 1
  s_mul_i32 s51, s49, 10240
  s_add_u32 s51, s51, 16384
  s_waitcnt lgkmcnt(0)
  s_mov_b32 s16, s4
  s_and_b32 s17, s5, 0xffff
  s_mov_b32 s18, 268435456
  s_mov_b32 s19, 0x00020000
  s_or_b32 s52, s2, s3
  s_cmp_lg_u32 s52, 0
  s_cbranch_scc1 concat_heads__grouped_kv_mqa__linear_kernel_hedgehog__prompt_kernel_nz
  v_lshlrev_b32 v184, 4, v1
  v_mov_b32 v186, 0
  v_mov_b32 v187, 0
  v_mov_b32 v188, 0
  v_mov_b32 v189, 0
  s_mov_b32 s52, 19922944
  buffer_store_dwordx4 v[186:189], v184, s[16:19], s52 offen sc0 sc1
  s_add_u32 s52, s52, 1024
  buffer_store_dwordx4 v[186:189], v184, s[16:19], s52 offen sc0 sc1
  s_add_u32 s52, s52, 1024
  buffer_store_dwordx4 v[186:189], v184, s[16:19], s52 offen sc0 sc1
  s_add_u32 s52, s52, 1024
  buffer_store_dwordx4 v[186:189], v184, s[16:19], s52 offen sc0 sc1
  s_add_u32 s52, s52, 1024
  buffer_store_dwordx4 v[186:189], v184, s[16:19], s52 offen sc0 sc1
  s_add_u32 s52, s52, 1024
  buffer_store_dwordx4 v[186:189], v184, s[16:19], s52 offen sc0 sc1
  s_add_u32 s52, s52, 1024
  buffer_store_dwordx4 v[186:189], v184, s[16:19], s52 offen sc0 sc1
  s_add_u32 s52, s52, 1024
  buffer_store_dwordx4 v[186:189], v184, s[16:19], s52 offen sc0 sc1
  s_add_u32 s52, s52, 1024
concat_heads__grouped_kv_mqa__linear_kernel_hedgehog__prompt_kernel_nz:
  v_and_b32 v174, 15, v1
  v_lshrrev_b32 v175, 4, v1
  v_and_b32 v176, 7, v174
  v_xor_b32 v176, v176, v175
  v_lshlrev_b32 v176, 4, v176
  v_lshl_add_u32 v176, v174, 7, v176
  v_add_u32 v168, s50, v176
  v_xor_b32 v169, 64, v168
  v_lshrrev_b32 v177, 1, v175
  v_lshlrev_b32 v177, 4, v177
  v_and_b32 v178, 1, v175
  v_lshl_add_u32 v177, v178, 2, v177
  v_lshrrev_b32 v178, 2, v174
  v_add_u32 v177, v177, v178
  v_mul_u32_u24 v177, 160, v177
  v_and_b32 v178, 3, v1
  v_mul_u32_u24 v178, 40, v178
  v_add_u32 v177, v177, v178
  v_add_u32 v170, s51, v177
  v_lshlrev_b32 v174, 4, v1
  v_add_u32 v174, 155648, v174
  v_mov_b32 v96, 0
  v_mov_b32 v97, 0
  v_mov_b32 v98, 0
  v_mov_b32 v99, 0
  ds_write_b128 v174, v[96:99]
  s_waitcnt lgkmcnt(0)
  v_mov_b32 v16, 0
  v_mov_b32 v17, 0
  v_mov_b32 v18, 0
  v_mov_b32 v19, 0
  v_mov_b32 v20, 0
  v_mov_b32 v21, 0
  v_mov_b32 v22, 0
  v_mov_b32 v23, 0
  v_mov_b32 v24, 0
  v_mov_b32 v25, 0
  v_mov_b32 v26, 0
  v_mov_b32 v27, 0
  v_mov_b32 v28, 0
  v_mov_b32 v29, 0
  v_mov_b32 v30, 0
  v_mov_b32 v31, 0
  v_mov_b32 v32, 0
  v_mov_b32 v33, 0
  v_mov_b32 v34, 0
  v_mov_b32 v35, 0
  v_mov_b32 v36, 0
  v_mov_b32 v37, 0
  v_mov_b32 v38, 0
  v_mov_b32 v39, 0
  v_mov_b32 v40, 0
  v_mov_b32 v41, 0
  v_mov_b32 v42, 0
  v_mov_b32 v43, 0
  v_mov_b32 v44, 0
  v_mov_b32 v45, 0
  v_mov_b32 v46, 0
  v_mov_b32 v47, 0
  v_mov_b32 v48, 0
  v_mov_b32 v49, 0
  v_mov_b32 v50, 0
  v_mov_b32 v51, 0
  v_mov_b32 v52, 0
  v_mov_b32 v53, 0
  v_mov_b32 v54, 0
  v_mov_b32 v55, 0
  v_mov_b32 v56, 0
  v_mov_b32 v57, 0
  v_mov_b32 v58, 0
  v_mov_b32 v59, 0
  v_mov_b32 v60, 0
  v_mov_b32 v61, 0
  v_mov_b32 v62, 0
  v_mov_b32 v63, 0
  v_mov_b32 v64, 0
  v_mov_b32 v65, 0
  v_mov_b32 v66, 0
  v_mov_b32 v67, 0
  v_mov_b32 v68, 0
  v_mov_b32 v69, 0
  v_mov_b32 v70, 0
  v_mov_b32 v71, 0
  v_mov_b32 v72, 0
  v_mov_b32 v73, 0
  v_mov_b32 v74, 0
  v_mov_b32 v75, 0
  v_mov_b32 v76, 0
  v_mov_b32 v77, 0
  v_mov_b32 v78, 0
  v_mov_b32 v79, 0
  v_mov_b32 v80, 0
  v_mov_b32 v81, 0
  v_mov_b32 v82, 0
  v_mov_b32 v83, 0
  v_mov_b32 v84, 0
  v_mov_b32 v85, 0
  v_mov_b32 v86, 0
  v_mov_b32 v87, 0
  v_mov_b32 v88, 0
  v_mov_b32 v89, 0
  v_mov_b32 v90, 0
  v_mov_b32 v91, 0
  v_mov_b32 v92, 0
  v_mov_b32 v93, 0
  v_mov_b32 v94, 0
  v_mov_b32 v95, 0
  s_mov_b32 s26, 0
  v_add_u32 v171, s26, v168
  v_add_u32 v172, s26, v169
  v_add_u32 v173, s26, v170
  s_mov_b32 s27, 10
  s_barrier
  ds_read_b128 v[96:99], v171 offset:0
  ds_read_b128 v[100:103], v171 offset:2048
  ds_read_b128 v[104:107], v171 offset:4096
  ds_read_b128 v[108:111], v171 offset:6144
  ds_read_b64_tr_b16 v[128:129], v173 offset:0
  ds_read_b64_tr_b16 v[130:131], v173 offset:1280
  ds_read_b64_tr_b16 v[132:133], v173 offset:8
  ds_read_b64_tr_b16 v[134:135], v173 offset:1288
  ds_read_b64_tr_b16 v[136:137], v173 offset:16
  ds_read_b64_tr_b16 v[138:139], v173 offset:1296
  ds_read_b64_tr_b16 v[140:141], v173 offset:24
  ds_read_b64_tr_b16 v[142:143], v173 offset:1304
  ds_read_b64_tr_b16 v[144:145], v173 offset:32
  ds_read_b64_tr_b16 v[146:147], v173 offset:1312
  s_cmp_eq_u32 s40, 0
  s_cbranch_scc1 concat_heads__grouped_kv_mqa__linear_kernel_hedgehog__prompt_kernel_prej
  s_and_b32 s50, s3, 1
  s_lshl_b32 s50, s50, 2
  s_cmp_ge_u32 s40, 2
  s_cselect_b32 s50, 0, s50
  s_mov_b32 s99, 147456
  v_lshrrev_b32 v174, 4, v1
  v_and_b32 v175, 3, v1
  v_cmp_eq_u32 vcc, v174, v175
  v_add_u32 v174, s50, v174
  v_mul_u32_u24 v174, 800, v174
  v_bfe_u32 v175, v1, 2, 2
  v_mul_u32_u24 v175, 40, v175
  v_add3_u32 v174, v174, v175, s99
  v_mov_b32 v175, 155648
  v_cndmask_b32 v180, v175, v174, vcc
  ds_read_b64_tr_b16 v[196:197], v180 offset:0
  ds_read_b64_tr_b16 v[198:199], v180 offset:160
  ds_read_b64_tr_b16 v[200:201], v180 offset:320
  ds_read_b64_tr_b16 v[202:203], v180 offset:480
  ds_read_b64_tr_b16 v[204:205], v180 offset:640
  v_mov_b32 v206, 0
  v_mov_b32 v207, 0
  ds_read_b64_tr_b16 v[208:209], v180 offset:8
  ds_read_b64_tr_b16 v[210:211], v180 offset:168
  ds_read_b64_tr_b16 v[212:213], v180 offset:328
  ds_read_b64_tr_b16 v[214:215], v180 offset:488
  ds_read_b64_tr_b16 v[216:217], v180 offset:648
  v_mov_b32 v218, 0
  v_mov_b32 v219, 0
  ds_read_b64_tr_b16 v[220:221], v180 offset:16
  ds_read_b64_tr_b16 v[222:223], v180 offset:176
  ds_read_b64_tr_b16 v[224:225], v180 offset:336
  ds_read_b64_tr_b16 v[226:227], v180 offset:496
  ds_read_b64_tr_b16 v[228:229], v180 offset:656
  v_mov_b32 v230, 0
  v_mov_b32 v231, 0
  ds_read_b64_tr_b16 v[232:233], v180 offset:24
  ds_read_b64_tr_b16 v[234:235], v180 offset:184
  ds_read_b64_tr_b16 v[236:237], v180 offset:344
  ds_read_b64_tr_b16 v[238:239], v180 offset:504
  ds_read_b64_tr_b16 v[240:241], v180 offset:664
  v_mov_b32 v242, 0
  v_mov_b32 v243, 0
  ds_read_b64_tr_b16 v[244:245], v180 offset:32
  ds_read_b64_tr_b16 v[246:247], v180 offset:192
  ds_read_b64_tr_b16 v[248:249], v180 offset:352
  ds_read_b64_tr_b16 v[250:251], v180 offset:512
  ds_read_b64_tr_b16 v[252:253], v180 offset:672
  v_mov_b32 v254, 0
  v_mov_b32 v255, 0
concat_heads__grouped_kv_mqa__linear_kernel_hedgehog__prompt_kernel_prej:
  .p2align 6
concat_heads__grouped_kv_mqa__linear_kernel_hedgehog__prompt_kernel_p1_kloop:
  s_waitcnt lgkmcnt(0)
  v_mfma_f32_16x16x32_bf16 v[16:19], v[128:131], v[96:99], v[16:19]
  ds_read_b128 v[112:115], v172 offset:0
  v_mfma_f32_16x16x32_bf16 v[20:23], v[128:131], v[100:103], v[20:23]
  ds_read_b128 v[116:119], v172 offset:2048
  v_mfma_f32_16x16x32_bf16 v[24:27], v[128:131], v[104:107], v[24:27]
  ds_read_b128 v[120:123], v172 offset:4096
  v_mfma_f32_16x16x32_bf16 v[28:31], v[128:131], v[108:111], v[28:31]
  ds_read_b128 v[124:127], v172 offset:6144
  v_mfma_f32_16x16x32_bf16 v[32:35], v[132:135], v[96:99], v[32:35]
  ds_read_b64_tr_b16 v[148:149], v173 offset:5120
  v_mfma_f32_16x16x32_bf16 v[36:39], v[132:135], v[100:103], v[36:39]
  ds_read_b64_tr_b16 v[150:151], v173 offset:6400
  v_mfma_f32_16x16x32_bf16 v[40:43], v[132:135], v[104:107], v[40:43]
  ds_read_b64_tr_b16 v[152:153], v173 offset:5128
  v_mfma_f32_16x16x32_bf16 v[44:47], v[132:135], v[108:111], v[44:47]
  ds_read_b64_tr_b16 v[154:155], v173 offset:6408
  v_mfma_f32_16x16x32_bf16 v[48:51], v[136:139], v[96:99], v[48:51]
  ds_read_b64_tr_b16 v[156:157], v173 offset:5136
  v_mfma_f32_16x16x32_bf16 v[52:55], v[136:139], v[100:103], v[52:55]
  ds_read_b64_tr_b16 v[158:159], v173 offset:6416
  v_mfma_f32_16x16x32_bf16 v[56:59], v[136:139], v[104:107], v[56:59]
  ds_read_b64_tr_b16 v[160:161], v173 offset:5144
  v_mfma_f32_16x16x32_bf16 v[60:63], v[136:139], v[108:111], v[60:63]
  ds_read_b64_tr_b16 v[162:163], v173 offset:6424
  v_mfma_f32_16x16x32_bf16 v[64:67], v[140:143], v[96:99], v[64:67]
  ds_read_b64_tr_b16 v[164:165], v173 offset:5152
  v_mfma_f32_16x16x32_bf16 v[68:71], v[140:143], v[100:103], v[68:71]
  ds_read_b64_tr_b16 v[166:167], v173 offset:6432
  v_mfma_f32_16x16x32_bf16 v[72:75], v[140:143], v[104:107], v[72:75]
  v_mfma_f32_16x16x32_bf16 v[76:79], v[140:143], v[108:111], v[76:79]
  v_mfma_f32_16x16x32_bf16 v[80:83], v[144:147], v[96:99], v[80:83]
  v_mfma_f32_16x16x32_bf16 v[84:87], v[144:147], v[100:103], v[84:87]
  v_mfma_f32_16x16x32_bf16 v[88:91], v[144:147], v[104:107], v[88:91]
  v_mfma_f32_16x16x32_bf16 v[92:95], v[144:147], v[108:111], v[92:95]
  s_waitcnt lgkmcnt(0)
  s_barrier
  v_mfma_f32_16x16x32_bf16 v[16:19], v[148:151], v[112:115], v[16:19]
  s_add_u32 s26, s26, 36864
  s_cmp_ge_u32 s26, 147456
  v_mfma_f32_16x16x32_bf16 v[20:23], v[148:151], v[116:119], v[20:23]
  s_cselect_b32 s26, 0, s26
  v_mfma_f32_16x16x32_bf16 v[24:27], v[148:151], v[120:123], v[24:27]
  v_add_u32 v171, s26, v168
  v_mfma_f32_16x16x32_bf16 v[28:31], v[148:151], v[124:127], v[28:31]
  v_add_u32 v172, s26, v169
  v_mfma_f32_16x16x32_bf16 v[32:35], v[152:155], v[112:115], v[32:35]
  v_add_u32 v173, s26, v170
  v_mfma_f32_16x16x32_bf16 v[36:39], v[152:155], v[116:119], v[36:39]
  ds_read_b128 v[96:99], v171 offset:0
  v_mfma_f32_16x16x32_bf16 v[40:43], v[152:155], v[120:123], v[40:43]
  ds_read_b128 v[100:103], v171 offset:2048
  v_mfma_f32_16x16x32_bf16 v[44:47], v[152:155], v[124:127], v[44:47]
  ds_read_b128 v[104:107], v171 offset:4096
  v_mfma_f32_16x16x32_bf16 v[48:51], v[156:159], v[112:115], v[48:51]
  ds_read_b128 v[108:111], v171 offset:6144
  v_mfma_f32_16x16x32_bf16 v[52:55], v[156:159], v[116:119], v[52:55]
  ds_read_b64_tr_b16 v[128:129], v173 offset:0
  v_mfma_f32_16x16x32_bf16 v[56:59], v[156:159], v[120:123], v[56:59]
  ds_read_b64_tr_b16 v[130:131], v173 offset:1280
  v_mfma_f32_16x16x32_bf16 v[60:63], v[156:159], v[124:127], v[60:63]
  ds_read_b64_tr_b16 v[132:133], v173 offset:8
  v_mfma_f32_16x16x32_bf16 v[64:67], v[160:163], v[112:115], v[64:67]
  ds_read_b64_tr_b16 v[134:135], v173 offset:1288
  v_mfma_f32_16x16x32_bf16 v[68:71], v[160:163], v[116:119], v[68:71]
  ds_read_b64_tr_b16 v[136:137], v173 offset:16
  v_mfma_f32_16x16x32_bf16 v[72:75], v[160:163], v[120:123], v[72:75]
  ds_read_b64_tr_b16 v[138:139], v173 offset:1296
  v_mfma_f32_16x16x32_bf16 v[76:79], v[160:163], v[124:127], v[76:79]
  ds_read_b64_tr_b16 v[140:141], v173 offset:24
  v_mfma_f32_16x16x32_bf16 v[80:83], v[164:167], v[112:115], v[80:83]
  ds_read_b64_tr_b16 v[142:143], v173 offset:1304
  v_mfma_f32_16x16x32_bf16 v[84:87], v[164:167], v[116:119], v[84:87]
  ds_read_b64_tr_b16 v[144:145], v173 offset:32
  v_mfma_f32_16x16x32_bf16 v[88:91], v[164:167], v[120:123], v[88:91]
  ds_read_b64_tr_b16 v[146:147], v173 offset:1312
  v_mfma_f32_16x16x32_bf16 v[92:95], v[164:167], v[124:127], v[92:95]
  s_sub_u32 s27, s27, 1
  s_cmp_lg_u32 s27, 0
  s_cbranch_scc1 concat_heads__grouped_kv_mqa__linear_kernel_hedgehog__prompt_kernel_p1_kloop
  s_waitcnt lgkmcnt(0)
  s_cmp_eq_u32 s40, 0
  s_cbranch_scc1 concat_heads__grouped_kv_mqa__linear_kernel_hedgehog__prompt_kernel_ra
  s_barrier
  s_cmp_eq_u32 s40, 1
  s_cbranch_scc1 concat_heads__grouped_kv_mqa__linear_kernel_hedgehog__prompt_kernel_rbq
  s_lshr_b32 s52, s3, 1
  s_and_b32 s53, s3, 1
  v_cvt_pk_bf16_f32 v96, v16, v17
  v_cvt_pk_bf16_f32 v97, v18, v19
  v_cvt_pk_bf16_f32 v98, v32, v33
  v_cvt_pk_bf16_f32 v99, v34, v35
  v_cvt_pk_bf16_f32 v100, v48, v49
  v_cvt_pk_bf16_f32 v101, v50, v51
  v_cvt_pk_bf16_f32 v102, v64, v65
  v_cvt_pk_bf16_f32 v103, v66, v67
  v_cvt_pk_bf16_f32 v104, v80, v81
  v_cvt_pk_bf16_f32 v105, v82, v83
  v_mov_b32 v106, 0
  v_mov_b32 v107, 0
  v_cvt_pk_bf16_f32 v108, v20, v21
  v_cvt_pk_bf16_f32 v109, v22, v23
  v_cvt_pk_bf16_f32 v110, v36, v37
  v_cvt_pk_bf16_f32 v111, v38, v39
  v_cvt_pk_bf16_f32 v112, v52, v53
  v_cvt_pk_bf16_f32 v113, v54, v55
  v_cvt_pk_bf16_f32 v114, v68, v69
  v_cvt_pk_bf16_f32 v115, v70, v71
  v_cvt_pk_bf16_f32 v116, v84, v85
  v_cvt_pk_bf16_f32 v117, v86, v87
  v_mov_b32 v118, 0
  v_mov_b32 v119, 0
  v_cvt_pk_bf16_f32 v120, v24, v25
  v_cvt_pk_bf16_f32 v121, v26, v27
  v_cvt_pk_bf16_f32 v122, v40, v41
  v_cvt_pk_bf16_f32 v123, v42, v43
  v_cvt_pk_bf16_f32 v124, v56, v57
  v_cvt_pk_bf16_f32 v125, v58, v59
  v_cvt_pk_bf16_f32 v126, v72, v73
  v_cvt_pk_bf16_f32 v127, v74, v75
  v_cvt_pk_bf16_f32 v128, v88, v89
  v_cvt_pk_bf16_f32 v129, v90, v91
  v_mov_b32 v130, 0
  v_mov_b32 v131, 0
  v_cvt_pk_bf16_f32 v132, v28, v29
  v_cvt_pk_bf16_f32 v133, v30, v31
  v_cvt_pk_bf16_f32 v134, v44, v45
  v_cvt_pk_bf16_f32 v135, v46, v47
  v_cvt_pk_bf16_f32 v136, v60, v61
  v_cvt_pk_bf16_f32 v137, v62, v63
  v_cvt_pk_bf16_f32 v138, v76, v77
  v_cvt_pk_bf16_f32 v139, v78, v79
  v_cvt_pk_bf16_f32 v140, v92, v93
  v_cvt_pk_bf16_f32 v141, v94, v95
  v_mov_b32 v142, 0
  v_mov_b32 v143, 0
  s_cmp_eq_u32 s53, 0
  s_cbranch_scc0 concat_heads__grouped_kv_mqa__linear_kernel_hedgehog__prompt_kernel_vw
  s_mul_i32 s54, s52, 5120
  v_lshlrev_b32 v174, 4, v1
  v_add_u32 v174, s54, v174
  v_lshlrev_b32 v175, 3, v1
  v_add_u32 v175, s54, v175
  ds_write_b128 v174, v[120:123] offset:26624
  ds_write_b128 v174, v[124:127] offset:27648
  ds_write_b64 v175, v[128:129] offset:28672
  ds_write_b128 v174, v[132:135] offset:29184
  ds_write_b128 v174, v[136:139] offset:30208
  ds_write_b64 v175, v[140:141] offset:31232
  s_waitcnt lgkmcnt(0)
  s_barrier
  s_branch concat_heads__grouped_kv_mqa__linear_kernel_hedgehog__prompt_kernel_go
concat_heads__grouped_kv_mqa__linear_kernel_hedgehog__prompt_kernel_vw:
  v_and_b32 v174, 15, v1
  v_mul_u32_u24 v174, 208, v174
  v_lshrrev_b32 v175, 4, v1
  v_mul_u32_u24 v175, 48, v175
  v_add_u32 v174, v174, v175
  s_mul_i32 s54, s52, 13312
  v_add_u32 v174, s54, v174
  v_mov_b32 v176, 0x3f80
  v_mov_b32 v177, 0
  ds_write_b128 v174, v[96:99] offset:0
  ds_write_b128 v174, v[100:103] offset:16
  ds_write_b64 v174, v[104:105] offset:32
  ds_write_b64 v174, v[176:177] offset:40
  ds_write_b128 v174, v[108:111] offset:3328
  ds_write_b128 v174, v[112:115] offset:3344
  ds_write_b64 v174, v[116:117] offset:3360
  ds_write_b64 v174, v[176:177] offset:3368
  ds_write_b128 v174, v[120:123] offset:6656
  ds_write_b128 v174, v[124:127] offset:6672
  ds_write_b64 v174, v[128:129] offset:6688
  ds_write_b64 v174, v[176:177] offset:6696
  ds_write_b128 v174, v[132:135] offset:9984
  ds_write_b128 v174, v[136:139] offset:10000
  ds_write_b64 v174, v[140:141] offset:10016
  ds_write_b64 v174, v[176:177] offset:10024
  s_waitcnt lgkmcnt(0)
  s_barrier
  s_mul_i32 s54, s52, 5120
  v_lshlrev_b32 v174, 4, v1
  v_add_u32 v174, s54, v174
  v_lshlrev_b32 v175, 3, v1
  v_add_u32 v175, s54, v175
  ds_read_b128 v[96:99], v174 offset:26624
  ds_read_b128 v[100:103], v174 offset:27648
  ds_read_b64 v[104:105], v175 offset:28672
  ds_read_b128 v[108:111], v174 offset:29184
  ds_read_b128 v[112:115], v174 offset:30208
  ds_read_b64 v[116:117], v175 offset:31232
  s_waitcnt lgkmcnt(0)
concat_heads__grouped_kv_mqa__linear_kernel_hedgehog__prompt_kernel_go:
  v_and_b32 v174, 15, v1
  v_mul_u32_u24 v174, 336, v174
  v_lshrrev_b32 v175, 4, v1
  v_mul_u32_u24 v175, 80, v175
  v_add_u32 v174, v174, v175
  s_lshl_b32 s54, s52, 6
  s_lshl_b32 s55, s53, 5
  s_add_u32 s54, s54, s55
  s_mul_i32 s54, s54, 336
  s_add_u32 s54, s54, 36864
  v_add_u32 v174, s54, v174
  s_mov_b32 s98, 0x3fb8aa3b
  v_mfma_f32_16x16x32_bf16 v[56:59], v[196:199], v[96:99], 0
  v_mfma_f32_16x16x32_bf16 v[60:63], v[208:211], v[96:99], 0
  v_mfma_f32_16x16x32_bf16 v[64:67], v[220:223], v[96:99], 0
  v_mfma_f32_16x16x32_bf16 v[68:71], v[232:235], v[96:99], 0
  v_mfma_f32_16x16x32_bf16 v[72:75], v[244:247], v[96:99], 0
  v_mfma_f32_16x16x32_bf16 v[56:59], v[200:203], v[100:103], v[56:59]
  v_mfma_f32_16x16x32_bf16 v[60:63], v[212:215], v[100:103], v[60:63]
  v_mfma_f32_16x16x32_bf16 v[64:67], v[224:227], v[100:103], v[64:67]
  v_mfma_f32_16x16x32_bf16 v[68:71], v[236:239], v[100:103], v[68:71]
  v_mfma_f32_16x16x32_bf16 v[72:75], v[248:251], v[100:103], v[72:75]
  v_mfma_f32_16x16x32_bf16 v[56:59], v[204:207], v[104:107], v[56:59]
  v_mfma_f32_16x16x32_bf16 v[60:63], v[216:219], v[104:107], v[60:63]
  v_mfma_f32_16x16x32_bf16 v[64:67], v[228:231], v[104:107], v[64:67]
  v_mfma_f32_16x16x32_bf16 v[68:71], v[240:243], v[104:107], v[68:71]
  v_mfma_f32_16x16x32_bf16 v[72:75], v[252:255], v[104:107], v[72:75]
  v_mfma_f32_16x16x32_bf16 v[76:79], v[196:199], v[108:111], 0
  v_mfma_f32_16x16x32_bf16 v[80:83], v[208:211], v[108:111], 0
  v_mfma_f32_16x16x32_bf16 v[84:87], v[220:223], v[108:111], 0
  v_mfma_f32_16x16x32_bf16 v[88:91], v[232:235], v[108:111], 0
  v_mfma_f32_16x16x32_bf16 v[92:95], v[244:247], v[108:111], 0
  v_mfma_f32_16x16x32_bf16 v[76:79], v[200:203], v[112:115], v[76:79]
  v_mfma_f32_16x16x32_bf16 v[80:83], v[212:215], v[112:115], v[80:83]
  v_mfma_f32_16x16x32_bf16 v[84:87], v[224:227], v[112:115], v[84:87]
  v_mfma_f32_16x16x32_bf16 v[88:91], v[236:239], v[112:115], v[88:91]
  v_mfma_f32_16x16x32_bf16 v[92:95], v[248:251], v[112:115], v[92:95]
  v_mfma_f32_16x16x32_bf16 v[76:79], v[204:207], v[116:119], v[76:79]
  v_mfma_f32_16x16x32_bf16 v[80:83], v[216:219], v[116:119], v[80:83]
  v_mfma_f32_16x16x32_bf16 v[84:87], v[228:231], v[116:119], v[84:87]
  v_mfma_f32_16x16x32_bf16 v[88:91], v[240:243], v[116:119], v[88:91]
  v_mfma_f32_16x16x32_bf16 v[92:95], v[252:255], v[116:119], v[92:95]
  s_nop 0
  v_max3_f32 v164, v56, v57, v58
  v_min3_f32 v165, v56, v57, v58
  v_max3_f32 v164, v164, v59, v60
  v_min3_f32 v165, v165, v59, v60
  v_max3_f32 v164, v164, v61, v62
  v_min3_f32 v165, v165, v61, v62
  v_max3_f32 v164, v164, v63, v64
  v_min3_f32 v165, v165, v63, v64
  v_max3_f32 v164, v164, v65, v66
  v_min3_f32 v165, v165, v65, v66
  v_max3_f32 v164, v164, v67, v68
  v_min3_f32 v165, v165, v67, v68
  v_max3_f32 v164, v164, v69, v70
  v_min3_f32 v165, v165, v69, v70
  v_max3_f32 v164, v164, v71, v72
  v_min3_f32 v165, v165, v71, v72
  v_max3_f32 v164, v164, v73, v74
  v_min3_f32 v165, v165, v73, v74
  v_max_f32 v164, v164, v75
  v_min_f32 v165, v165, v75
  v_mul_f32 v164, 0xbfb8aa3b, v164
  v_mul_f32 v165, 0x3fb8aa3b, v165
  v_fma_f32 v144, -v56, s98, v165
  v_fma_f32 v56, v56, s98, v164
  v_fma_f32 v145, -v57, s98, v165
  v_fma_f32 v57, v57, s98, v164
  v_fma_f32 v146, -v58, s98, v165
  v_fma_f32 v58, v58, s98, v164
  v_fma_f32 v147, -v59, s98, v165
  v_fma_f32 v59, v59, s98, v164
  v_fma_f32 v148, -v60, s98, v165
  v_fma_f32 v60, v60, s98, v164
  v_fma_f32 v149, -v61, s98, v165
  v_fma_f32 v61, v61, s98, v164
  v_fma_f32 v150, -v62, s98, v165
  v_fma_f32 v62, v62, s98, v164
  v_fma_f32 v151, -v63, s98, v165
  v_fma_f32 v63, v63, s98, v164
  v_fma_f32 v152, -v64, s98, v165
  v_fma_f32 v64, v64, s98, v164
  v_fma_f32 v153, -v65, s98, v165
  v_fma_f32 v65, v65, s98, v164
  v_fma_f32 v154, -v66, s98, v165
  v_fma_f32 v66, v66, s98, v164
  v_fma_f32 v155, -v67, s98, v165
  v_fma_f32 v67, v67, s98, v164
  v_fma_f32 v156, -v68, s98, v165
  v_fma_f32 v68, v68, s98, v164
  v_fma_f32 v157, -v69, s98, v165
  v_fma_f32 v69, v69, s98, v164
  v_fma_f32 v158, -v70, s98, v165
  v_fma_f32 v70, v70, s98, v164
  v_fma_f32 v159, -v71, s98, v165
  v_fma_f32 v71, v71, s98, v164
  v_fma_f32 v160, -v72, s98, v165
  v_fma_f32 v72, v72, s98, v164
  v_fma_f32 v161, -v73, s98, v165
  v_fma_f32 v73, v73, s98, v164
  v_fma_f32 v162, -v74, s98, v165
  v_fma_f32 v74, v74, s98, v164
  v_fma_f32 v163, -v75, s98, v165
  v_fma_f32 v75, v75, s98, v164
  v_exp_f32 v56, v56
  v_exp_f32 v144, v144
  v_exp_f32 v57, v57
  v_exp_f32 v145, v145
  v_exp_f32 v58, v58
  v_exp_f32 v146, v146
  v_exp_f32 v59, v59
  v_exp_f32 v147, v147
  v_exp_f32 v60, v60
  v_exp_f32 v148, v148
  v_exp_f32 v61, v61
  v_exp_f32 v149, v149
  v_exp_f32 v62, v62
  v_exp_f32 v150, v150
  v_exp_f32 v63, v63
  v_exp_f32 v151, v151
  v_exp_f32 v64, v64
  v_exp_f32 v152, v152
  v_exp_f32 v65, v65
  v_exp_f32 v153, v153
  v_exp_f32 v66, v66
  v_exp_f32 v154, v154
  v_exp_f32 v67, v67
  v_exp_f32 v155, v155
  v_exp_f32 v68, v68
  v_exp_f32 v156, v156
  v_exp_f32 v69, v69
  v_exp_f32 v157, v157
  v_exp_f32 v70, v70
  v_exp_f32 v158, v158
  v_exp_f32 v71, v71
  v_exp_f32 v159, v159
  v_exp_f32 v72, v72
  v_exp_f32 v160, v160
  v_exp_f32 v73, v73
  v_exp_f32 v161, v161
  v_exp_f32 v74, v74
  v_exp_f32 v162, v162
  v_exp_f32 v75, v75
  v_exp_f32 v163, v163
  v_pk_add_f32 v[166:167], v[56:57], v[58:59]
  v_pk_add_f32 v[168:169], v[144:145], v[146:147]
  v_pk_add_f32 v[166:167], v[166:167], v[60:61]
  v_pk_add_f32 v[168:169], v[168:169], v[148:149]
  v_pk_add_f32 v[166:167], v[166:167], v[62:63]
  v_pk_add_f32 v[168:169], v[168:169], v[150:151]
  v_pk_add_f32 v[166:167], v[166:167], v[64:65]
  v_pk_add_f32 v[168:169], v[168:169], v[152:153]
  v_pk_add_f32 v[166:167], v[166:167], v[66:67]
  v_pk_add_f32 v[168:169], v[168:169], v[154:155]
  v_pk_add_f32 v[166:167], v[166:167], v[68:69]
  v_pk_add_f32 v[168:169], v[168:169], v[156:157]
  v_pk_add_f32 v[166:167], v[166:167], v[70:71]
  v_pk_add_f32 v[168:169], v[168:169], v[158:159]
  v_pk_add_f32 v[166:167], v[166:167], v[72:73]
  v_pk_add_f32 v[168:169], v[168:169], v[160:161]
  v_pk_add_f32 v[166:167], v[166:167], v[74:75]
  v_pk_add_f32 v[168:169], v[168:169], v[162:163]
  v_add_f32 v166, v166, v167
  v_add_f32 v168, v168, v169
  v_rcp_f32 v166, v166
  v_rcp_f32 v168, v168
  s_nop 0
  v_pk_mul_f32 v[56:57], v[56:57], v[166:167] op_sel_hi:[1,0]
  v_pk_mul_f32 v[144:145], v[144:145], v[168:169] op_sel_hi:[1,0]
  v_pk_mul_f32 v[58:59], v[58:59], v[166:167] op_sel_hi:[1,0]
  v_pk_mul_f32 v[146:147], v[146:147], v[168:169] op_sel_hi:[1,0]
  v_pk_mul_f32 v[60:61], v[60:61], v[166:167] op_sel_hi:[1,0]
  v_pk_mul_f32 v[148:149], v[148:149], v[168:169] op_sel_hi:[1,0]
  v_pk_mul_f32 v[62:63], v[62:63], v[166:167] op_sel_hi:[1,0]
  v_pk_mul_f32 v[150:151], v[150:151], v[168:169] op_sel_hi:[1,0]
  v_pk_mul_f32 v[64:65], v[64:65], v[166:167] op_sel_hi:[1,0]
  v_pk_mul_f32 v[152:153], v[152:153], v[168:169] op_sel_hi:[1,0]
  v_pk_mul_f32 v[66:67], v[66:67], v[166:167] op_sel_hi:[1,0]
  v_pk_mul_f32 v[154:155], v[154:155], v[168:169] op_sel_hi:[1,0]
  v_pk_mul_f32 v[68:69], v[68:69], v[166:167] op_sel_hi:[1,0]
  v_pk_mul_f32 v[156:157], v[156:157], v[168:169] op_sel_hi:[1,0]
  v_pk_mul_f32 v[70:71], v[70:71], v[166:167] op_sel_hi:[1,0]
  v_pk_mul_f32 v[158:159], v[158:159], v[168:169] op_sel_hi:[1,0]
  v_pk_mul_f32 v[72:73], v[72:73], v[166:167] op_sel_hi:[1,0]
  v_pk_mul_f32 v[160:161], v[160:161], v[168:169] op_sel_hi:[1,0]
  v_pk_mul_f32 v[74:75], v[74:75], v[166:167] op_sel_hi:[1,0]
  v_pk_mul_f32 v[162:163], v[162:163], v[168:169] op_sel_hi:[1,0]
  v_cvt_pk_bf16_f32 v120, v56, v57
  v_cvt_pk_bf16_f32 v121, v58, v59
  v_cvt_pk_bf16_f32 v122, v60, v61
  v_cvt_pk_bf16_f32 v123, v62, v63
  v_cvt_pk_bf16_f32 v124, v64, v65
  v_cvt_pk_bf16_f32 v125, v66, v67
  v_cvt_pk_bf16_f32 v126, v68, v69
  v_cvt_pk_bf16_f32 v127, v70, v71
  v_cvt_pk_bf16_f32 v128, v72, v73
  v_cvt_pk_bf16_f32 v129, v74, v75
  v_cvt_pk_bf16_f32 v130, v144, v145
  v_cvt_pk_bf16_f32 v131, v146, v147
  v_cvt_pk_bf16_f32 v132, v148, v149
  v_cvt_pk_bf16_f32 v133, v150, v151
  v_cvt_pk_bf16_f32 v134, v152, v153
  v_cvt_pk_bf16_f32 v135, v154, v155
  v_cvt_pk_bf16_f32 v136, v156, v157
  v_cvt_pk_bf16_f32 v137, v158, v159
  v_cvt_pk_bf16_f32 v138, v160, v161
  v_cvt_pk_bf16_f32 v139, v162, v163
  ds_write_b128 v174, v[120:123] offset:0
  ds_write_b128 v174, v[124:127] offset:16
  ds_write_b128 v174, v[128:131] offset:32
  ds_write_b128 v174, v[132:135] offset:48
  ds_write_b128 v174, v[136:139] offset:64
  s_nop 1
  v_max3_f32 v164, v76, v77, v78
  v_min3_f32 v165, v76, v77, v78
  v_max3_f32 v164, v164, v79, v80
  v_min3_f32 v165, v165, v79, v80
  v_max3_f32 v164, v164, v81, v82
  v_min3_f32 v165, v165, v81, v82
  v_max3_f32 v164, v164, v83, v84
  v_min3_f32 v165, v165, v83, v84
  v_max3_f32 v164, v164, v85, v86
  v_min3_f32 v165, v165, v85, v86
  v_max3_f32 v164, v164, v87, v88
  v_min3_f32 v165, v165, v87, v88
  v_max3_f32 v164, v164, v89, v90
  v_min3_f32 v165, v165, v89, v90
  v_max3_f32 v164, v164, v91, v92
  v_min3_f32 v165, v165, v91, v92
  v_max3_f32 v164, v164, v93, v94
  v_min3_f32 v165, v165, v93, v94
  v_max_f32 v164, v164, v95
  v_min_f32 v165, v165, v95
  v_mul_f32 v164, 0xbfb8aa3b, v164
  v_mul_f32 v165, 0x3fb8aa3b, v165
  v_fma_f32 v144, -v76, s98, v165
  v_fma_f32 v76, v76, s98, v164
  v_fma_f32 v145, -v77, s98, v165
  v_fma_f32 v77, v77, s98, v164
  v_fma_f32 v146, -v78, s98, v165
  v_fma_f32 v78, v78, s98, v164
  v_fma_f32 v147, -v79, s98, v165
  v_fma_f32 v79, v79, s98, v164
  v_fma_f32 v148, -v80, s98, v165
  v_fma_f32 v80, v80, s98, v164
  v_fma_f32 v149, -v81, s98, v165
  v_fma_f32 v81, v81, s98, v164
  v_fma_f32 v150, -v82, s98, v165
  v_fma_f32 v82, v82, s98, v164
  v_fma_f32 v151, -v83, s98, v165
  v_fma_f32 v83, v83, s98, v164
  v_fma_f32 v152, -v84, s98, v165
  v_fma_f32 v84, v84, s98, v164
  v_fma_f32 v153, -v85, s98, v165
  v_fma_f32 v85, v85, s98, v164
  v_fma_f32 v154, -v86, s98, v165
  v_fma_f32 v86, v86, s98, v164
  v_fma_f32 v155, -v87, s98, v165
  v_fma_f32 v87, v87, s98, v164
  v_fma_f32 v156, -v88, s98, v165
  v_fma_f32 v88, v88, s98, v164
  v_fma_f32 v157, -v89, s98, v165
  v_fma_f32 v89, v89, s98, v164
  v_fma_f32 v158, -v90, s98, v165
  v_fma_f32 v90, v90, s98, v164
  v_fma_f32 v159, -v91, s98, v165
  v_fma_f32 v91, v91, s98, v164
  v_fma_f32 v160, -v92, s98, v165
  v_fma_f32 v92, v92, s98, v164
  v_fma_f32 v161, -v93, s98, v165
  v_fma_f32 v93, v93, s98, v164
  v_fma_f32 v162, -v94, s98, v165
  v_fma_f32 v94, v94, s98, v164
  v_fma_f32 v163, -v95, s98, v165
  v_fma_f32 v95, v95, s98, v164
  v_exp_f32 v76, v76
  v_exp_f32 v144, v144
  v_exp_f32 v77, v77
  v_exp_f32 v145, v145
  v_exp_f32 v78, v78
  v_exp_f32 v146, v146
  v_exp_f32 v79, v79
  v_exp_f32 v147, v147
  v_exp_f32 v80, v80
  v_exp_f32 v148, v148
  v_exp_f32 v81, v81
  v_exp_f32 v149, v149
  v_exp_f32 v82, v82
  v_exp_f32 v150, v150
  v_exp_f32 v83, v83
  v_exp_f32 v151, v151
  v_exp_f32 v84, v84
  v_exp_f32 v152, v152
  v_exp_f32 v85, v85
  v_exp_f32 v153, v153
  v_exp_f32 v86, v86
  v_exp_f32 v154, v154
  v_exp_f32 v87, v87
  v_exp_f32 v155, v155
  v_exp_f32 v88, v88
  v_exp_f32 v156, v156
  v_exp_f32 v89, v89
  v_exp_f32 v157, v157
  v_exp_f32 v90, v90
  v_exp_f32 v158, v158
  v_exp_f32 v91, v91
  v_exp_f32 v159, v159
  v_exp_f32 v92, v92
  v_exp_f32 v160, v160
  v_exp_f32 v93, v93
  v_exp_f32 v161, v161
  v_exp_f32 v94, v94
  v_exp_f32 v162, v162
  v_exp_f32 v95, v95
  v_exp_f32 v163, v163
  v_pk_add_f32 v[166:167], v[76:77], v[78:79]
  v_pk_add_f32 v[168:169], v[144:145], v[146:147]
  v_pk_add_f32 v[166:167], v[166:167], v[80:81]
  v_pk_add_f32 v[168:169], v[168:169], v[148:149]
  v_pk_add_f32 v[166:167], v[166:167], v[82:83]
  v_pk_add_f32 v[168:169], v[168:169], v[150:151]
  v_pk_add_f32 v[166:167], v[166:167], v[84:85]
  v_pk_add_f32 v[168:169], v[168:169], v[152:153]
  v_pk_add_f32 v[166:167], v[166:167], v[86:87]
  v_pk_add_f32 v[168:169], v[168:169], v[154:155]
  v_pk_add_f32 v[166:167], v[166:167], v[88:89]
  v_pk_add_f32 v[168:169], v[168:169], v[156:157]
  v_pk_add_f32 v[166:167], v[166:167], v[90:91]
  v_pk_add_f32 v[168:169], v[168:169], v[158:159]
  v_pk_add_f32 v[166:167], v[166:167], v[92:93]
  v_pk_add_f32 v[168:169], v[168:169], v[160:161]
  v_pk_add_f32 v[166:167], v[166:167], v[94:95]
  v_pk_add_f32 v[168:169], v[168:169], v[162:163]
  v_add_f32 v166, v166, v167
  v_add_f32 v168, v168, v169
  v_rcp_f32 v166, v166
  v_rcp_f32 v168, v168
  s_nop 0
  v_pk_mul_f32 v[76:77], v[76:77], v[166:167] op_sel_hi:[1,0]
  v_pk_mul_f32 v[144:145], v[144:145], v[168:169] op_sel_hi:[1,0]
  v_pk_mul_f32 v[78:79], v[78:79], v[166:167] op_sel_hi:[1,0]
  v_pk_mul_f32 v[146:147], v[146:147], v[168:169] op_sel_hi:[1,0]
  v_pk_mul_f32 v[80:81], v[80:81], v[166:167] op_sel_hi:[1,0]
  v_pk_mul_f32 v[148:149], v[148:149], v[168:169] op_sel_hi:[1,0]
  v_pk_mul_f32 v[82:83], v[82:83], v[166:167] op_sel_hi:[1,0]
  v_pk_mul_f32 v[150:151], v[150:151], v[168:169] op_sel_hi:[1,0]
  v_pk_mul_f32 v[84:85], v[84:85], v[166:167] op_sel_hi:[1,0]
  v_pk_mul_f32 v[152:153], v[152:153], v[168:169] op_sel_hi:[1,0]
  v_pk_mul_f32 v[86:87], v[86:87], v[166:167] op_sel_hi:[1,0]
  v_pk_mul_f32 v[154:155], v[154:155], v[168:169] op_sel_hi:[1,0]
  v_pk_mul_f32 v[88:89], v[88:89], v[166:167] op_sel_hi:[1,0]
  v_pk_mul_f32 v[156:157], v[156:157], v[168:169] op_sel_hi:[1,0]
  v_pk_mul_f32 v[90:91], v[90:91], v[166:167] op_sel_hi:[1,0]
  v_pk_mul_f32 v[158:159], v[158:159], v[168:169] op_sel_hi:[1,0]
  v_pk_mul_f32 v[92:93], v[92:93], v[166:167] op_sel_hi:[1,0]
  v_pk_mul_f32 v[160:161], v[160:161], v[168:169] op_sel_hi:[1,0]
  v_pk_mul_f32 v[94:95], v[94:95], v[166:167] op_sel_hi:[1,0]
  v_pk_mul_f32 v[162:163], v[162:163], v[168:169] op_sel_hi:[1,0]
  v_cvt_pk_bf16_f32 v120, v76, v77
  v_cvt_pk_bf16_f32 v121, v78, v79
  v_cvt_pk_bf16_f32 v122, v80, v81
  v_cvt_pk_bf16_f32 v123, v82, v83
  v_cvt_pk_bf16_f32 v124, v84, v85
  v_cvt_pk_bf16_f32 v125, v86, v87
  v_cvt_pk_bf16_f32 v126, v88, v89
  v_cvt_pk_bf16_f32 v127, v90, v91
  v_cvt_pk_bf16_f32 v128, v92, v93
  v_cvt_pk_bf16_f32 v129, v94, v95
  v_cvt_pk_bf16_f32 v130, v144, v145
  v_cvt_pk_bf16_f32 v131, v146, v147
  v_cvt_pk_bf16_f32 v132, v148, v149
  v_cvt_pk_bf16_f32 v133, v150, v151
  v_cvt_pk_bf16_f32 v134, v152, v153
  v_cvt_pk_bf16_f32 v135, v154, v155
  v_cvt_pk_bf16_f32 v136, v156, v157
  v_cvt_pk_bf16_f32 v137, v158, v159
  v_cvt_pk_bf16_f32 v138, v160, v161
  v_cvt_pk_bf16_f32 v139, v162, v163
  ds_write_b128 v174, v[120:123] offset:5376
  ds_write_b128 v174, v[124:127] offset:5392
  ds_write_b128 v174, v[128:131] offset:5408
  ds_write_b128 v174, v[132:135] offset:5424
  ds_write_b128 v174, v[136:139] offset:5440
  s_nop 1
  s_waitcnt lgkmcnt(0)
  s_barrier
  v_lshrrev_b32 v174, 4, v1
  v_lshlrev_b32 v174, 3, v174
  v_bfe_u32 v175, v1, 2, 2
  v_add_u32 v174, v174, v175
  v_and_b32 v175, 3, v1
  v_lshlrev_b32 v175, 3, v175
  v_mul_u32_u24 v176, 208, v174
  v_add_u32 v176, v176, v175
  s_mul_i32 s54, s3, 48
  v_add_u32 v176, s54, v176
  v_mul_u32_u24 v177, 336, v174
  v_add_u32 v177, v177, v175
  s_mul_i32 s54, s3, 80
  s_add_u32 s54, s54, 36864
  v_add_u32 v177, s54, v177
  ds_read_b64_tr_b16 v[40:41], v176 offset:0
  ds_read_b64_tr_b16 v[42:43], v176 offset:832
  ds_read_b64_tr_b16 v[44:45], v176 offset:32
  ds_read_b64_tr_b16 v[46:47], v176 offset:864
  ds_read_b64_tr_b16 v[56:57], v177 offset:0
  ds_read_b64_tr_b16 v[58:59], v177 offset:1344
  ds_read_b64_tr_b16 v[60:61], v177 offset:32
  ds_read_b64_tr_b16 v[62:63], v177 offset:1376
  ds_read_b64_tr_b16 v[64:65], v177 offset:64
  ds_read_b64_tr_b16 v[66:67], v177 offset:1408
  ds_read_b64_tr_b16 v[48:49], v176 offset:6656
  ds_read_b64_tr_b16 v[50:51], v176 offset:7488
  ds_read_b64_tr_b16 v[52:53], v176 offset:6688
  ds_read_b64_tr_b16 v[54:55], v176 offset:7520
  ds_read_b64_tr_b16 v[68:69], v177 offset:10752
  ds_read_b64_tr_b16 v[70:71], v177 offset:12096
  ds_read_b64_tr_b16 v[72:73], v177 offset:10784
  ds_read_b64_tr_b16 v[74:75], v177 offset:12128
  ds_read_b64_tr_b16 v[76:77], v177 offset:10816
  ds_read_b64_tr_b16 v[78:79], v177 offset:12160
  s_waitcnt lgkmcnt(10)
  v_mfma_f32_16x16x32_bf16 v[16:19], v[40:43], v[56:59], 0
  v_mfma_f32_16x16x32_bf16 v[20:23], v[40:43], v[60:63], 0
  v_mfma_f32_16x16x32_bf16 v[24:27], v[40:43], v[64:67], 0
  v_mfma_f32_16x16x32_bf16 v[28:31], v[44:47], v[56:59], 0
  v_mfma_f32_16x16x32_bf16 v[32:35], v[44:47], v[60:63], 0
  v_mfma_f32_16x16x32_bf16 v[36:39], v[44:47], v[64:67], 0
  ds_read_b64_tr_b16 v[40:41], v176 offset:13312
  ds_read_b64_tr_b16 v[42:43], v176 offset:14144
  ds_read_b64_tr_b16 v[44:45], v176 offset:13344
  ds_read_b64_tr_b16 v[46:47], v176 offset:14176
  ds_read_b64_tr_b16 v[56:57], v177 offset:21504
  ds_read_b64_tr_b16 v[58:59], v177 offset:22848
  ds_read_b64_tr_b16 v[60:61], v177 offset:21536
  ds_read_b64_tr_b16 v[62:63], v177 offset:22880
  ds_read_b64_tr_b16 v[64:65], v177 offset:21568
  ds_read_b64_tr_b16 v[66:67], v177 offset:22912
  s_waitcnt lgkmcnt(10)
  v_mfma_f32_16x16x32_bf16 v[16:19], v[48:51], v[68:71], v[16:19]
  v_mfma_f32_16x16x32_bf16 v[20:23], v[48:51], v[72:75], v[20:23]
  v_mfma_f32_16x16x32_bf16 v[24:27], v[48:51], v[76:79], v[24:27]
  v_mfma_f32_16x16x32_bf16 v[28:31], v[52:55], v[68:71], v[28:31]
  v_mfma_f32_16x16x32_bf16 v[32:35], v[52:55], v[72:75], v[32:35]
  v_mfma_f32_16x16x32_bf16 v[36:39], v[52:55], v[76:79], v[36:39]
  ds_read_b64_tr_b16 v[48:49], v176 offset:19968
  ds_read_b64_tr_b16 v[50:51], v176 offset:20800
  ds_read_b64_tr_b16 v[52:53], v176 offset:20000
  ds_read_b64_tr_b16 v[54:55], v176 offset:20832
  ds_read_b64_tr_b16 v[68:69], v177 offset:32256
  ds_read_b64_tr_b16 v[70:71], v177 offset:33600
  ds_read_b64_tr_b16 v[72:73], v177 offset:32288
  ds_read_b64_tr_b16 v[74:75], v177 offset:33632
  ds_read_b64_tr_b16 v[76:77], v177 offset:32320
  ds_read_b64_tr_b16 v[78:79], v177 offset:33664
  s_waitcnt lgkmcnt(10)
  v_mfma_f32_16x16x32_bf16 v[16:19], v[40:43], v[56:59], v[16:19]
  v_mfma_f32_16x16x32_bf16 v[20:23], v[40:43], v[60:63], v[20:23]
  v_mfma_f32_16x16x32_bf16 v[24:27], v[40:43], v[64:67], v[24:27]
  v_mfma_f32_16x16x32_bf16 v[28:31], v[44:47], v[56:59], v[28:31]
  v_mfma_f32_16x16x32_bf16 v[32:35], v[44:47], v[60:63], v[32:35]
  v_mfma_f32_16x16x32_bf16 v[36:39], v[44:47], v[64:67], v[36:39]
  s_waitcnt lgkmcnt(0)
  v_mfma_f32_16x16x32_bf16 v[16:19], v[48:51], v[68:71], v[16:19]
  v_mfma_f32_16x16x32_bf16 v[20:23], v[48:51], v[72:75], v[20:23]
  v_mfma_f32_16x16x32_bf16 v[24:27], v[48:51], v[76:79], v[24:27]
  v_mfma_f32_16x16x32_bf16 v[28:31], v[52:55], v[68:71], v[28:31]
  v_mfma_f32_16x16x32_bf16 v[32:35], v[52:55], v[72:75], v[32:35]
  v_mfma_f32_16x16x32_bf16 v[36:39], v[52:55], v[76:79], v[36:39]
  s_sub_u32 s54, s40, 2
  s_lshl_b32 s54, s54, 2
  s_add_u32 s54, s54, s42
  s_lshl_b32 s54, s54, 4
  s_add_u32 s54, s54, s41
  s_lshl_b32 s54, s54, 2
  s_add_u32 s54, s54, s3
  s_mul_i32 s54, s54, 3840
  s_add_u32 s54, s54, 16777216
  v_and_b32 v174, 15, v1
  v_lshrrev_b32 v175, 4, v1
  v_mul_u32_u24 v176, 96, v174
  v_lshl_add_u32 v176, v175, 4, v176
  v_mov_b32 v177, 0x7f000000
  v_cmp_gt_u32 vcc, 2, v175
  s_nop 1
  v_cndmask_b32 v178, v177, v176, vcc
  v_cmp_gt_u32 vcc, 8, v174
  s_nop 1
  v_cndmask_b32 v179, v177, v176, vcc
  v_cndmask_b32 v180, v177, v178, vcc
  s_nop 4
  buffer_store_dwordx4 v[16:19], v176, s[16:19], s54 offen offset:0 sc0 sc1
  buffer_store_dwordx4 v[20:23], v176, s[16:19], s54 offen offset:1536 sc0 sc1
  buffer_store_dwordx4 v[24:27], v179, s[16:19], s54 offen offset:3072 sc0 sc1
  buffer_store_dwordx4 v[28:31], v178, s[16:19], s54 offen offset:64 sc0 sc1
  buffer_store_dwordx4 v[32:35], v178, s[16:19], s54 offen offset:1600 sc0 sc1
  buffer_store_dwordx4 v[36:39], v180, s[16:19], s54 offen offset:3136 sc0 sc1
concat_heads__grouped_kv_mqa__linear_kernel_hedgehog__prompt_kernel_fin:
  s_barrier
  s_mov_b32 s3, s100
  v_mov_b32 v2, v1
  s_mov_b32 s38, -1
  s_mov_b32 s39, 0
  v_lshlrev_b32 v120, 4, v2
  v_lshlrev_b32 v121, 3, v2
  s_mov_b32 s8, s4
  s_and_b32 s9, s5, 0xffff
  s_mov_b32 s10, 268435456
  s_mov_b32 s11, 0x00020000
  s_mov_b32 s101, 0
  s_mul_i32 s22, s3, 28672
  s_add_u32 s21, s22, 28672
  s_mov_b32 s20, s22
  v_add_u32 v122, s20, v120
  v_add_u32 v123, s20, v121
  v_mov_b32 v128, 0
  v_mov_b32 v129, 0
  v_mov_b32 v130, 0
  v_mov_b32 v131, 0
  v_mov_b32 v132, 0
  v_mov_b32 v133, 0
  v_mov_b32 v134, 0
  v_mov_b32 v135, 0
  v_mov_b32 v136, 0
  v_mov_b32 v137, 0
  v_mov_b32 v138, 0
  v_mov_b32 v139, 0
  v_mov_b32 v140, 0
  v_mov_b32 v141, 0
  v_mov_b32 v142, 0
  v_mov_b32 v143, 0
  v_mov_b32 v144, 0
  v_mov_b32 v145, 0
  v_mov_b32 v146, 0
  v_mov_b32 v147, 0
  v_mov_b32 v148, 0
  v_mov_b32 v149, 0
  v_mov_b32 v150, 0
  v_mov_b32 v151, 0
  v_mov_b32 v152, 0
  v_mov_b32 v153, 0
  v_mov_b32 v154, 0
  v_mov_b32 v155, 0
  v_mov_b32 v156, 0
  v_mov_b32 v157, 0
  v_mov_b32 v158, 0
  v_mov_b32 v159, 0
  v_mov_b32 v160, 0
  v_mov_b32 v161, 0
  v_mov_b32 v162, 0
  v_mov_b32 v163, 0
  v_mov_b32 v164, 0
  v_mov_b32 v165, 0
  v_mov_b32 v166, 0
  v_mov_b32 v167, 0
  v_mov_b32 v168, 0
  v_mov_b32 v169, 0
  v_mov_b32 v170, 0
  v_mov_b32 v171, 0
  v_mov_b32 v172, 0
  v_mov_b32 v173, 0
  v_mov_b32 v174, 0
  v_mov_b32 v175, 0
  v_mov_b32 v176, 0
  v_mov_b32 v177, 0
  v_mov_b32 v178, 0
  v_mov_b32 v179, 0
  v_mov_b32 v180, 0
  v_mov_b32 v181, 0
  v_mov_b32 v182, 0
  v_mov_b32 v183, 0
  v_mov_b32 v184, 0
  v_mov_b32 v185, 0
  v_mov_b32 v186, 0
  v_mov_b32 v187, 0
  v_mov_b32 v188, 0
  v_mov_b32 v189, 0
  v_mov_b32 v190, 0
  v_mov_b32 v191, 0
  v_mov_b32 v192, 0
  v_mov_b32 v193, 0
  v_mov_b32 v194, 0
  v_mov_b32 v195, 0
  v_mov_b32 v196, 0
  v_mov_b32 v197, 0
  v_mov_b32 v198, 0
  v_mov_b32 v199, 0
  v_mov_b32 v200, 0
  v_mov_b32 v201, 0
  v_mov_b32 v202, 0
  v_mov_b32 v203, 0
  v_mov_b32 v204, 0
  v_mov_b32 v205, 0
  v_mov_b32 v206, 0
  v_mov_b32 v207, 0
  v_mov_b32 v208, 0
  v_mov_b32 v209, 0
  v_mov_b32 v210, 0
  v_mov_b32 v211, 0
  v_mov_b32 v212, 0
  v_mov_b32 v213, 0
  v_mov_b32 v214, 0
  v_mov_b32 v215, 0
  v_mov_b32 v216, 0
  v_mov_b32 v217, 0
  v_mov_b32 v218, 0
  v_mov_b32 v219, 0
  v_mov_b32 v220, 0
  v_mov_b32 v221, 0
  v_mov_b32 v222, 0
  v_mov_b32 v223, 0
  v_mov_b32 v224, 0
  v_mov_b32 v225, 0
  v_mov_b32 v226, 0
  v_mov_b32 v227, 0
  v_mov_b32 v228, 0
  v_mov_b32 v229, 0
  v_mov_b32 v230, 0
  v_mov_b32 v231, 0
  v_mov_b32 v232, 0
  v_mov_b32 v233, 0
  v_mov_b32 v234, 0
  v_mov_b32 v235, 0
  v_mov_b32 v236, 0
  v_mov_b32 v237, 0
  v_mov_b32 v238, 0
  v_mov_b32 v239, 0
  v_mov_b32 v240, 0
  v_mov_b32 v241, 0
  v_mov_b32 v242, 0
  v_mov_b32 v243, 0
  v_mov_b32 v244, 0
  v_mov_b32 v245, 0
  v_mov_b32 v246, 0
  v_mov_b32 v247, 0
  v_mov_b32 v248, 0
  v_mov_b32 v249, 0
  v_mov_b32 v250, 0
  v_mov_b32 v251, 0
  v_mov_b32 v252, 0
  v_mov_b32 v253, 0
  v_mov_b32 v254, 0
  v_mov_b32 v255, 0
  v_mov_b32 v84, 0
  v_mov_b32 v85, 0
  v_mov_b32 v86, 0
  v_mov_b32 v87, 0
  v_mov_b32 v88, 0
  v_mov_b32 v89, 0
  v_mov_b32 v90, 0
  v_mov_b32 v91, 0
  v_mov_b32 v114, 0
  v_mov_b32 v115, 0
  v_mov_b32 v116, 0
  v_mov_b32 v117, 0
  v_add_u32 v126, 114688, v120
  v_and_b32 v127, 31, v2
  v_lshlrev_b32 v127, 4, v127
  v_lshrrev_b32 v3, 5, v2
  v_lshl_add_u32 v127, v3, 3, v127
  v_add_u32 v127, 115712, v127
  v_add_u32 v3, 146944, v121
  s_barrier
  s_waitcnt vmcnt(0)
  s_barrier
  ds_read_b64 v[124:125], v3
  ds_read_b128 v[92:95], v122
  ds_read_b64 v[104:105], v123 offset:3072
  ds_read_b128 v[96:99], v122 offset:1024
  ds_read_b128 v[100:103], v122 offset:2048
  ds_read_b128 v[4:7], v126 offset:0
  ds_read_b64 v[36:37], v127 offset:0
  ds_read_b128 v[8:11], v126 offset:1536
  ds_read_b64 v[38:39], v127 offset:1536
  ds_read_b128 v[12:15], v126 offset:3072
  ds_read_b64 v[40:41], v127 offset:3072
  ds_read_b128 v[16:19], v126 offset:4608
  ds_read_b64 v[42:43], v127 offset:4608
  ds_read_b128 v[20:23], v126 offset:6144
  ds_read_b64 v[44:45], v127 offset:6144
  ds_read_b128 v[24:27], v126 offset:7680
  ds_read_b64 v[46:47], v127 offset:7680
  ds_read_b128 v[28:31], v126 offset:9216
  ds_read_b64 v[48:49], v127 offset:9216
  ds_read_b128 v[32:35], v126 offset:10752
  ds_read_b64 v[50:51], v127 offset:10752
  s_add_u32 s20, s20, 3584
  s_cmp_ge_u32 s20, s21
  s_cselect_b32 s20, s22, s20
  v_add_u32 v122, s20, v120
  v_add_u32 v123, s20, v121
  s_waitcnt lgkmcnt(0)
  v_max_f32 v124, v124, v125
  s_nop 1
  v_max_f32_dpp v124, v124, v124 row_shr:1 row_mask:0xf bank_mask:0xf
  s_nop 1
  v_max_f32_dpp v124, v124, v124 row_shr:2 row_mask:0xf bank_mask:0xf
  s_nop 1
  v_max_f32_dpp v124, v124, v124 row_shr:4 row_mask:0xf bank_mask:0xf
  s_nop 1
  v_max_f32_dpp v124, v124, v124 row_shr:8 row_mask:0xf bank_mask:0xf
  s_nop 1
  v_max_f32_dpp v124, v124, v124 row_bcast:15 row_mask:0xa bank_mask:0xf
  s_nop 1
  v_max_f32_dpp v124, v124, v124 row_bcast:31 row_mask:0xc bank_mask:0xf
  s_nop 1
  v_readlane_b32 s24, v124, 63
  v_cmp_gt_u32 vcc, 32, v2
  s_nop 1
  v_mov_b32 v124, s24
  v_sqrt_f32 v124, v124
  s_nop 0
  v_mul_f32 v124, 0x3f808312, v124
  v_mul_f32 v126, v124, v36
  v_add_u32 v126, 0xffff, v126
  v_lshrrev_b32 v126, 16, v126
  v_or_b32 v126, 0x8000, v126
  v_cndmask_b32 v36, v126, v36, vcc
  v_mul_f32 v127, v124, v38
  v_add_u32 v127, 0xffff, v127
  v_lshrrev_b32 v127, 16, v127
  v_or_b32 v127, 0x8000, v127
  v_cndmask_b32 v38, v127, v38, vcc
  v_mul_f32 v126, v124, v40
  v_add_u32 v126, 0xffff, v126
  v_lshrrev_b32 v126, 16, v126
  v_or_b32 v126, 0x8000, v126
  v_cndmask_b32 v40, v126, v40, vcc
  v_mul_f32 v127, v124, v42
  v_add_u32 v127, 0xffff, v127
  v_lshrrev_b32 v127, 16, v127
  v_or_b32 v127, 0x8000, v127
  v_cndmask_b32 v42, v127, v42, vcc
  v_mul_f32 v126, v124, v44
  v_add_u32 v126, 0xffff, v126
  v_lshrrev_b32 v126, 16, v126
  v_or_b32 v126, 0x8000, v126
  v_cndmask_b32 v44, v126, v44, vcc
  v_mul_f32 v127, v124, v46
  v_add_u32 v127, 0xffff, v127
  v_lshrrev_b32 v127, 16, v127
  v_or_b32 v127, 0x8000, v127
  v_cndmask_b32 v46, v127, v46, vcc
  v_mul_f32 v126, v124, v48
  v_add_u32 v126, 0xffff, v126
  v_lshrrev_b32 v126, 16, v126
  v_or_b32 v126, 0x8000, v126
  v_cndmask_b32 v48, v126, v48, vcc
  v_mul_f32 v127, v124, v50
  v_add_u32 v127, 0xffff, v127
  v_lshrrev_b32 v127, 16, v127
  v_or_b32 v127, 0x8000, v127
  v_cndmask_b32 v50, v127, v50, vcc
  s_nop 1
  v_mfma_f32_32x32x16_bf16 v[52:67], v[92:95], v[4:7], 0
  v_mfma_f32_32x32x8_bf16 v[52:67], v[104:105], v[36:37], v[52:67]
  s_mov_b32 s25, 8
  .p2align 6
concat_heads__grouped_kv_mqa__linear_kernel_hedgehog__prompt_kernel_loop:
  v_mfma_f32_32x32x16_bf16 v[68:83], v[92:95], v[8:11], 0
  v_exp_f32 v52, v52
  v_exp_f32 v53, v53
  v_exp_f32 v54, v54
  v_exp_f32 v55, v55
  v_mfma_f32_32x32x16_bf16 v[240:255], v[114:117], v[88:91], v[240:255]
  v_exp_f32 v56, v56
  v_exp_f32 v57, v57
  v_exp_f32 v58, v58
  v_exp_f32 v59, v59
  v_mfma_f32_32x32x8_bf16 v[68:83], v[104:105], v[38:39], v[68:83]
  v_cvt_pk_bf16_f32 v84, v52, v53
  v_cvt_pk_bf16_f32 v85, v54, v55
  v_cvt_pk_bf16_f32 v86, v56, v57
  v_cvt_pk_bf16_f32 v87, v58, v59
  v_exp_f32 v60, v60
  v_exp_f32 v61, v61
  v_exp_f32 v62, v62
  v_exp_f32 v63, v63
  v_mfma_f32_32x32x16_bf16 v[128:143], v[96:99], v[84:87], v[128:143]
  v_exp_f32 v64, v64
  v_exp_f32 v65, v65
  v_exp_f32 v66, v66
  v_exp_f32 v67, v67
  v_cvt_pk_bf16_f32 v88, v60, v61
  v_cvt_pk_bf16_f32 v89, v62, v63
  v_cvt_pk_bf16_f32 v90, v64, v65
  v_cvt_pk_bf16_f32 v91, v66, v67
  v_mfma_f32_32x32x16_bf16 v[52:67], v[92:95], v[12:15], 0
  v_exp_f32 v68, v68
  v_exp_f32 v69, v69
  v_exp_f32 v70, v70
  v_exp_f32 v71, v71
  v_mfma_f32_32x32x16_bf16 v[128:143], v[100:103], v[88:91], v[128:143]
  v_exp_f32 v72, v72
  v_exp_f32 v73, v73
  v_exp_f32 v74, v74
  v_exp_f32 v75, v75
  v_mfma_f32_32x32x8_bf16 v[52:67], v[104:105], v[40:41], v[52:67]
  v_cvt_pk_bf16_f32 v84, v68, v69
  v_cvt_pk_bf16_f32 v85, v70, v71
  v_cvt_pk_bf16_f32 v86, v72, v73
  v_cvt_pk_bf16_f32 v87, v74, v75
  ds_read_b128 v[106:109], v122
  ds_read_b64 v[118:119], v123 offset:3072
  ds_read_b128 v[110:113], v122 offset:1024
  ds_read_b128 v[114:117], v122 offset:2048
  v_exp_f32 v76, v76
  v_exp_f32 v77, v77
  v_exp_f32 v78, v78
  v_exp_f32 v79, v79
  v_mfma_f32_32x32x16_bf16 v[144:159], v[96:99], v[84:87], v[144:159]
  v_exp_f32 v80, v80
  v_exp_f32 v81, v81
  v_exp_f32 v82, v82
  v_exp_f32 v83, v83
  v_cvt_pk_bf16_f32 v88, v76, v77
  v_cvt_pk_bf16_f32 v89, v78, v79
  v_cvt_pk_bf16_f32 v90, v80, v81
  v_cvt_pk_bf16_f32 v91, v82, v83
  v_mfma_f32_32x32x16_bf16 v[68:83], v[92:95], v[16:19], 0
  v_exp_f32 v52, v52
  v_exp_f32 v53, v53
  v_exp_f32 v54, v54
  v_exp_f32 v55, v55
  v_mfma_f32_32x32x16_bf16 v[144:159], v[100:103], v[88:91], v[144:159]
  v_exp_f32 v56, v56
  v_exp_f32 v57, v57
  v_exp_f32 v58, v58
  v_exp_f32 v59, v59
  v_mfma_f32_32x32x8_bf16 v[68:83], v[104:105], v[42:43], v[68:83]
  v_cvt_pk_bf16_f32 v84, v52, v53
  v_cvt_pk_bf16_f32 v85, v54, v55
  v_cvt_pk_bf16_f32 v86, v56, v57
  v_cvt_pk_bf16_f32 v87, v58, v59
  s_add_u32 s20, s20, 3584
  s_cmp_ge_u32 s20, s21
  s_cselect_b32 s20, s22, s20
  v_add_u32 v122, s20, v120
  v_add_u32 v123, s20, v121
  v_exp_f32 v60, v60
  v_exp_f32 v61, v61
  v_exp_f32 v62, v62
  v_exp_f32 v63, v63
  v_mfma_f32_32x32x16_bf16 v[160:175], v[96:99], v[84:87], v[160:175]
  v_exp_f32 v64, v64
  v_exp_f32 v65, v65
  v_exp_f32 v66, v66
  v_exp_f32 v67, v67
  v_cvt_pk_bf16_f32 v88, v60, v61
  v_cvt_pk_bf16_f32 v89, v62, v63
  v_cvt_pk_bf16_f32 v90, v64, v65
  v_cvt_pk_bf16_f32 v91, v66, v67
  v_mfma_f32_32x32x16_bf16 v[52:67], v[92:95], v[20:23], 0
  v_exp_f32 v68, v68
  v_exp_f32 v69, v69
  v_exp_f32 v70, v70
  v_exp_f32 v71, v71
  v_mfma_f32_32x32x16_bf16 v[160:175], v[100:103], v[88:91], v[160:175]
  v_exp_f32 v72, v72
  v_exp_f32 v73, v73
  v_exp_f32 v74, v74
  v_exp_f32 v75, v75
  v_mfma_f32_32x32x8_bf16 v[52:67], v[104:105], v[44:45], v[52:67]
  v_cvt_pk_bf16_f32 v84, v68, v69
  v_cvt_pk_bf16_f32 v85, v70, v71
  v_cvt_pk_bf16_f32 v86, v72, v73
  v_cvt_pk_bf16_f32 v87, v74, v75
  v_exp_f32 v76, v76
  v_exp_f32 v77, v77
  v_exp_f32 v78, v78
  v_exp_f32 v79, v79
  v_mfma_f32_32x32x16_bf16 v[176:191], v[96:99], v[84:87], v[176:191]
  v_exp_f32 v80, v80
  v_exp_f32 v81, v81
  v_exp_f32 v82, v82
  v_exp_f32 v83, v83
  v_cvt_pk_bf16_f32 v88, v76, v77
  v_cvt_pk_bf16_f32 v89, v78, v79
  v_cvt_pk_bf16_f32 v90, v80, v81
  v_cvt_pk_bf16_f32 v91, v82, v83
  v_mfma_f32_32x32x16_bf16 v[68:83], v[92:95], v[24:27], 0
  v_exp_f32 v52, v52
  v_exp_f32 v53, v53
  v_exp_f32 v54, v54
  v_exp_f32 v55, v55
  v_mfma_f32_32x32x16_bf16 v[176:191], v[100:103], v[88:91], v[176:191]
  v_exp_f32 v56, v56
  v_exp_f32 v57, v57
  v_exp_f32 v58, v58
  v_exp_f32 v59, v59
  v_mfma_f32_32x32x8_bf16 v[68:83], v[104:105], v[46:47], v[68:83]
  v_cvt_pk_bf16_f32 v84, v52, v53
  v_cvt_pk_bf16_f32 v85, v54, v55
  v_cvt_pk_bf16_f32 v86, v56, v57
  v_cvt_pk_bf16_f32 v87, v58, v59
  v_exp_f32 v60, v60
  v_exp_f32 v61, v61
  v_exp_f32 v62, v62
  v_exp_f32 v63, v63
  v_mfma_f32_32x32x16_bf16 v[192:207], v[96:99], v[84:87], v[192:207]
  v_exp_f32 v64, v64
  v_exp_f32 v65, v65
  v_exp_f32 v66, v66
  v_exp_f32 v67, v67
  v_cvt_pk_bf16_f32 v88, v60, v61
  v_cvt_pk_bf16_f32 v89, v62, v63
  v_cvt_pk_bf16_f32 v90, v64, v65
  v_cvt_pk_bf16_f32 v91, v66, v67
  v_mfma_f32_32x32x16_bf16 v[52:67], v[92:95], v[28:31], 0
  v_exp_f32 v68, v68
  v_exp_f32 v69, v69
  v_exp_f32 v70, v70
  v_exp_f32 v71, v71
  v_mfma_f32_32x32x16_bf16 v[192:207], v[100:103], v[88:91], v[192:207]
  v_exp_f32 v72, v72
  v_exp_f32 v73, v73
  v_exp_f32 v74, v74
  v_exp_f32 v75, v75
  v_mfma_f32_32x32x8_bf16 v[52:67], v[104:105], v[48:49], v[52:67]
  v_cvt_pk_bf16_f32 v84, v68, v69
  v_cvt_pk_bf16_f32 v85, v70, v71
  v_cvt_pk_bf16_f32 v86, v72, v73
  v_cvt_pk_bf16_f32 v87, v74, v75
  v_exp_f32 v76, v76
  v_exp_f32 v77, v77
  v_exp_f32 v78, v78
  v_exp_f32 v79, v79
  v_mfma_f32_32x32x16_bf16 v[208:223], v[96:99], v[84:87], v[208:223]
  v_exp_f32 v80, v80
  v_exp_f32 v81, v81
  v_exp_f32 v82, v82
  v_exp_f32 v83, v83
  v_cvt_pk_bf16_f32 v88, v76, v77
  v_cvt_pk_bf16_f32 v89, v78, v79
  v_cvt_pk_bf16_f32 v90, v80, v81
  v_cvt_pk_bf16_f32 v91, v82, v83
  v_mfma_f32_32x32x16_bf16 v[68:83], v[92:95], v[32:35], 0
  v_exp_f32 v52, v52
  v_exp_f32 v53, v53
  v_exp_f32 v54, v54
  v_exp_f32 v55, v55
  v_mfma_f32_32x32x16_bf16 v[208:223], v[100:103], v[88:91], v[208:223]
  v_exp_f32 v56, v56
  v_exp_f32 v57, v57
  v_exp_f32 v58, v58
  v_exp_f32 v59, v59
  v_mfma_f32_32x32x8_bf16 v[68:83], v[104:105], v[50:51], v[68:83]
  v_cvt_pk_bf16_f32 v84, v52, v53
  v_cvt_pk_bf16_f32 v85, v54, v55
  v_cvt_pk_bf16_f32 v86, v56, v57
  v_cvt_pk_bf16_f32 v87, v58, v59
  v_exp_f32 v60, v60
  v_exp_f32 v61, v61
  v_exp_f32 v62, v62
  v_exp_f32 v63, v63
  v_mfma_f32_32x32x16_bf16 v[224:239], v[96:99], v[84:87], v[224:239]
  v_exp_f32 v64, v64
  v_exp_f32 v65, v65
  v_exp_f32 v66, v66
  v_exp_f32 v67, v67
  v_cvt_pk_bf16_f32 v88, v60, v61
  v_cvt_pk_bf16_f32 v89, v62, v63
  v_cvt_pk_bf16_f32 v90, v64, v65
  v_cvt_pk_bf16_f32 v91, v66, v67
  s_waitcnt lgkmcnt(0)
  v_mfma_f32_32x32x16_bf16 v[52:67], v[106:109], v[4:7], 0
  v_exp_f32 v68, v68
  v_exp_f32 v69, v69
  v_exp_f32 v70, v70
  v_exp_f32 v71, v71
  v_mfma_f32_32x32x16_bf16 v[224:239], v[100:103], v[88:91], v[224:239]
  v_exp_f32 v72, v72
  v_exp_f32 v73, v73
  v_exp_f32 v74, v74
  v_exp_f32 v75, v75
  v_mfma_f32_32x32x8_bf16 v[52:67], v[118:119], v[36:37], v[52:67]
  v_cvt_pk_bf16_f32 v84, v68, v69
  v_cvt_pk_bf16_f32 v85, v70, v71
  v_cvt_pk_bf16_f32 v86, v72, v73
  v_cvt_pk_bf16_f32 v87, v74, v75
  v_exp_f32 v76, v76
  v_exp_f32 v77, v77
  v_exp_f32 v78, v78
  v_exp_f32 v79, v79
  v_mfma_f32_32x32x16_bf16 v[240:255], v[96:99], v[84:87], v[240:255]
  v_exp_f32 v80, v80
  v_exp_f32 v81, v81
  v_exp_f32 v82, v82
  v_exp_f32 v83, v83
  v_cvt_pk_bf16_f32 v88, v76, v77
  v_cvt_pk_bf16_f32 v89, v78, v79
  v_cvt_pk_bf16_f32 v90, v80, v81
  v_cvt_pk_bf16_f32 v91, v82, v83
  s_bitcmp1_b32 s25, 0
  s_cbranch_scc1 concat_heads__grouped_kv_mqa__linear_kernel_hedgehog__prompt_kernel_nobar
  s_barrier
concat_heads__grouped_kv_mqa__linear_kernel_hedgehog__prompt_kernel_nobar:
  v_mfma_f32_32x32x16_bf16 v[68:83], v[106:109], v[8:11], 0
  v_exp_f32 v52, v52
  v_exp_f32 v53, v53
  v_exp_f32 v54, v54
  v_exp_f32 v55, v55
  v_mfma_f32_32x32x16_bf16 v[240:255], v[100:103], v[88:91], v[240:255]
  v_exp_f32 v56, v56
  v_exp_f32 v57, v57
  v_exp_f32 v58, v58
  v_exp_f32 v59, v59
  v_mfma_f32_32x32x8_bf16 v[68:83], v[118:119], v[38:39], v[68:83]
  v_cvt_pk_bf16_f32 v84, v52, v53
  v_cvt_pk_bf16_f32 v85, v54, v55
  v_cvt_pk_bf16_f32 v86, v56, v57
  v_cvt_pk_bf16_f32 v87, v58, v59
  v_exp_f32 v60, v60
  v_exp_f32 v61, v61
  v_exp_f32 v62, v62
  v_exp_f32 v63, v63
  v_mfma_f32_32x32x16_bf16 v[128:143], v[110:113], v[84:87], v[128:143]
  v_exp_f32 v64, v64
  v_exp_f32 v65, v65
  v_exp_f32 v66, v66
  v_exp_f32 v67, v67
  v_cvt_pk_bf16_f32 v88, v60, v61
  v_cvt_pk_bf16_f32 v89, v62, v63
  v_cvt_pk_bf16_f32 v90, v64, v65
  v_cvt_pk_bf16_f32 v91, v66, v67
  v_mfma_f32_32x32x16_bf16 v[52:67], v[106:109], v[12:15], 0
  v_exp_f32 v68, v68
  v_exp_f32 v69, v69
  v_exp_f32 v70, v70
  v_exp_f32 v71, v71
  v_mfma_f32_32x32x16_bf16 v[128:143], v[114:117], v[88:91], v[128:143]
  v_exp_f32 v72, v72
  v_exp_f32 v73, v73
  v_exp_f32 v74, v74
  v_exp_f32 v75, v75
  v_mfma_f32_32x32x8_bf16 v[52:67], v[118:119], v[40:41], v[52:67]
  v_cvt_pk_bf16_f32 v84, v68, v69
  v_cvt_pk_bf16_f32 v85, v70, v71
  v_cvt_pk_bf16_f32 v86, v72, v73
  v_cvt_pk_bf16_f32 v87, v74, v75
  ds_read_b128 v[92:95], v122
  ds_read_b64 v[104:105], v123 offset:3072
  ds_read_b128 v[96:99], v122 offset:1024
  ds_read_b128 v[100:103], v122 offset:2048
  v_exp_f32 v76, v76
  v_exp_f32 v77, v77
  v_exp_f32 v78, v78
  v_exp_f32 v79, v79
  v_mfma_f32_32x32x16_bf16 v[144:159], v[110:113], v[84:87], v[144:159]
  v_exp_f32 v80, v80
  v_exp_f32 v81, v81
  v_exp_f32 v82, v82
  v_exp_f32 v83, v83
  v_cvt_pk_bf16_f32 v88, v76, v77
  v_cvt_pk_bf16_f32 v89, v78, v79
  v_cvt_pk_bf16_f32 v90, v80, v81
  v_cvt_pk_bf16_f32 v91, v82, v83
  v_mfma_f32_32x32x16_bf16 v[68:83], v[106:109], v[16:19], 0
  v_exp_f32 v52, v52
  v_exp_f32 v53, v53
  v_exp_f32 v54, v54
  v_exp_f32 v55, v55
  v_mfma_f32_32x32x16_bf16 v[144:159], v[114:117], v[88:91], v[144:159]
  v_exp_f32 v56, v56
  v_exp_f32 v57, v57
  v_exp_f32 v58, v58
  v_exp_f32 v59, v59
  v_mfma_f32_32x32x8_bf16 v[68:83], v[118:119], v[42:43], v[68:83]
  v_cvt_pk_bf16_f32 v84, v52, v53
  v_cvt_pk_bf16_f32 v85, v54, v55
  v_cvt_pk_bf16_f32 v86, v56, v57
  v_cvt_pk_bf16_f32 v87, v58, v59
  s_add_u32 s20, s20, 3584
  s_cmp_ge_u32 s20, s21
  s_cselect_b32 s20, s22, s20
  v_add_u32 v122, s20, v120
  v_add_u32 v123, s20, v121
  v_exp_f32 v60, v60
  v_exp_f32 v61, v61
  v_exp_f32 v62, v62
  v_exp_f32 v63, v63
  v_mfma_f32_32x32x16_bf16 v[160:175], v[110:113], v[84:87], v[160:175]
  v_exp_f32 v64, v64
  v_exp_f32 v65, v65
  v_exp_f32 v66, v66
  v_exp_f32 v67, v67
  v_cvt_pk_bf16_f32 v88, v60, v61
  v_cvt_pk_bf16_f32 v89, v62, v63
  v_cvt_pk_bf16_f32 v90, v64, v65
  v_cvt_pk_bf16_f32 v91, v66, v67
  v_mfma_f32_32x32x16_bf16 v[52:67], v[106:109], v[20:23], 0
  v_exp_f32 v68, v68
  v_exp_f32 v69, v69
  v_exp_f32 v70, v70
  v_exp_f32 v71, v71
  v_mfma_f32_32x32x16_bf16 v[160:175], v[114:117], v[88:91], v[160:175]
  v_exp_f32 v72, v72
  v_exp_f32 v73, v73
  v_exp_f32 v74, v74
  v_exp_f32 v75, v75
  v_mfma_f32_32x32x8_bf16 v[52:67], v[118:119], v[44:45], v[52:67]
  v_cvt_pk_bf16_f32 v84, v68, v69
  v_cvt_pk_bf16_f32 v85, v70, v71
  v_cvt_pk_bf16_f32 v86, v72, v73
  v_cvt_pk_bf16_f32 v87, v74, v75
  v_exp_f32 v76, v76
  v_exp_f32 v77, v77
  v_exp_f32 v78, v78
  v_exp_f32 v79, v79
  v_mfma_f32_32x32x16_bf16 v[176:191], v[110:113], v[84:87], v[176:191]
  v_exp_f32 v80, v80
  v_exp_f32 v81, v81
  v_exp_f32 v82, v82
  v_exp_f32 v83, v83
  v_cvt_pk_bf16_f32 v88, v76, v77
  v_cvt_pk_bf16_f32 v89, v78, v79
  v_cvt_pk_bf16_f32 v90, v80, v81
  v_cvt_pk_bf16_f32 v91, v82, v83
  v_mfma_f32_32x32x16_bf16 v[68:83], v[106:109], v[24:27], 0
  v_exp_f32 v52, v52
  v_exp_f32 v53, v53
  v_exp_f32 v54, v54
  v_exp_f32 v55, v55
  v_mfma_f32_32x32x16_bf16 v[176:191], v[114:117], v[88:91], v[176:191]
  v_exp_f32 v56, v56
  v_exp_f32 v57, v57
  v_exp_f32 v58, v58
  v_exp_f32 v59, v59
  v_mfma_f32_32x32x8_bf16 v[68:83], v[118:119], v[46:47], v[68:83]
  v_cvt_pk_bf16_f32 v84, v52, v53
  v_cvt_pk_bf16_f32 v85, v54, v55
  v_cvt_pk_bf16_f32 v86, v56, v57
  v_cvt_pk_bf16_f32 v87, v58, v59
  v_exp_f32 v60, v60
  v_exp_f32 v61, v61
  v_exp_f32 v62, v62
  v_exp_f32 v63, v63
  v_mfma_f32_32x32x16_bf16 v[192:207], v[110:113], v[84:87], v[192:207]
  v_exp_f32 v64, v64
  v_exp_f32 v65, v65
  v_exp_f32 v66, v66
  v_exp_f32 v67, v67
  v_cvt_pk_bf16_f32 v88, v60, v61
  v_cvt_pk_bf16_f32 v89, v62, v63
  v_cvt_pk_bf16_f32 v90, v64, v65
  v_cvt_pk_bf16_f32 v91, v66, v67
  v_mfma_f32_32x32x16_bf16 v[52:67], v[106:109], v[28:31], 0
  v_exp_f32 v68, v68
  v_exp_f32 v69, v69
  v_exp_f32 v70, v70
  v_exp_f32 v71, v71
  v_mfma_f32_32x32x16_bf16 v[192:207], v[114:117], v[88:91], v[192:207]
  v_exp_f32 v72, v72
  v_exp_f32 v73, v73
  v_exp_f32 v74, v74
  v_exp_f32 v75, v75
  v_mfma_f32_32x32x8_bf16 v[52:67], v[118:119], v[48:49], v[52:67]
  v_cvt_pk_bf16_f32 v84, v68, v69
  v_cvt_pk_bf16_f32 v85, v70, v71
  v_cvt_pk_bf16_f32 v86, v72, v73
  v_cvt_pk_bf16_f32 v87, v74, v75
  v_exp_f32 v76, v76
  v_exp_f32 v77, v77
  v_exp_f32 v78, v78
  v_exp_f32 v79, v79
  v_mfma_f32_32x32x16_bf16 v[208:223], v[110:113], v[84:87], v[208:223]
  v_exp_f32 v80, v80
  v_exp_f32 v81, v81
  v_exp_f32 v82, v82
  v_exp_f32 v83, v83
  v_cvt_pk_bf16_f32 v88, v76, v77
  v_cvt_pk_bf16_f32 v89, v78, v79
  v_cvt_pk_bf16_f32 v90, v80, v81
  v_cvt_pk_bf16_f32 v91, v82, v83
  v_mfma_f32_32x32x16_bf16 v[68:83], v[106:109], v[32:35], 0
  v_exp_f32 v52, v52
  v_exp_f32 v53, v53
  v_exp_f32 v54, v54
  v_exp_f32 v55, v55
  v_mfma_f32_32x32x16_bf16 v[208:223], v[114:117], v[88:91], v[208:223]
  v_exp_f32 v56, v56
  v_exp_f32 v57, v57
  v_exp_f32 v58, v58
  v_exp_f32 v59, v59
  v_mfma_f32_32x32x8_bf16 v[68:83], v[118:119], v[50:51], v[68:83]
  v_cvt_pk_bf16_f32 v84, v52, v53
  v_cvt_pk_bf16_f32 v85, v54, v55
  v_cvt_pk_bf16_f32 v86, v56, v57
  v_cvt_pk_bf16_f32 v87, v58, v59
  v_exp_f32 v60, v60
  v_exp_f32 v61, v61
  v_exp_f32 v62, v62
  v_exp_f32 v63, v63
  v_mfma_f32_32x32x16_bf16 v[224:239], v[110:113], v[84:87], v[224:239]
  v_exp_f32 v64, v64
  v_exp_f32 v65, v65
  v_exp_f32 v66, v66
  v_exp_f32 v67, v67
  v_cvt_pk_bf16_f32 v88, v60, v61
  v_cvt_pk_bf16_f32 v89, v62, v63
  v_cvt_pk_bf16_f32 v90, v64, v65
  v_cvt_pk_bf16_f32 v91, v66, v67
  s_waitcnt lgkmcnt(0)
  v_mfma_f32_32x32x16_bf16 v[52:67], v[92:95], v[4:7], 0
  v_exp_f32 v68, v68
  v_exp_f32 v69, v69
  v_exp_f32 v70, v70
  v_exp_f32 v71, v71
  v_mfma_f32_32x32x16_bf16 v[224:239], v[114:117], v[88:91], v[224:239]
  v_exp_f32 v72, v72
  v_exp_f32 v73, v73
  v_exp_f32 v74, v74
  v_exp_f32 v75, v75
  v_mfma_f32_32x32x8_bf16 v[52:67], v[104:105], v[36:37], v[52:67]
  v_cvt_pk_bf16_f32 v84, v68, v69
  v_cvt_pk_bf16_f32 v85, v70, v71
  v_cvt_pk_bf16_f32 v86, v72, v73
  v_cvt_pk_bf16_f32 v87, v74, v75
  v_exp_f32 v76, v76
  v_exp_f32 v77, v77
  v_exp_f32 v78, v78
  v_exp_f32 v79, v79
  v_mfma_f32_32x32x16_bf16 v[240:255], v[110:113], v[84:87], v[240:255]
  v_exp_f32 v80, v80
  v_exp_f32 v81, v81
  v_exp_f32 v82, v82
  v_exp_f32 v83, v83
  v_cvt_pk_bf16_f32 v88, v76, v77
  v_cvt_pk_bf16_f32 v89, v78, v79
  v_cvt_pk_bf16_f32 v90, v80, v81
  v_cvt_pk_bf16_f32 v91, v82, v83
  s_sub_u32 s25, s25, 1
  s_cmp_lg_u32 s25, 0
  s_cbranch_scc1 concat_heads__grouped_kv_mqa__linear_kernel_hedgehog__prompt_kernel_loop
  s_nop 1
  v_mfma_f32_32x32x16_bf16 v[240:255], v[114:117], v[88:91], v[240:255]
concat_heads__grouped_kv_mqa__linear_kernel_hedgehog__prompt_kernel_epi:
  s_nop 15
  s_nop 3
  s_mul_i32 s26, s3, 28672
  v_add_u32 v104, s26, v120
  s_cmp_lg_u32 s3, 0
  s_cbranch_scc1 concat_heads__grouped_kv_mqa__linear_kernel_hedgehog__prompt_kernel_own0
  ds_write_b128 v104, v[160:163] offset:6144
  ds_write_b128 v104, v[164:167] offset:7168
  ds_write_b128 v104, v[168:171] offset:8192
  ds_write_b128 v104, v[176:179] offset:9216
  ds_write_b128 v104, v[180:183] offset:10240
  ds_write_b128 v104, v[184:187] offset:11264
  ds_write_b128 v104, v[192:195] offset:12288
  ds_write_b128 v104, v[196:199] offset:13312
  ds_write_b128 v104, v[200:203] offset:14336
  ds_write_b128 v104, v[208:211] offset:15360
  ds_write_b128 v104, v[212:215] offset:16384
  ds_write_b128 v104, v[216:219] offset:17408
  ds_write_b128 v104, v[224:227] offset:18432
  ds_write_b128 v104, v[228:231] offset:19456
  ds_write_b128 v104, v[232:235] offset:20480
  ds_write_b128 v104, v[240:243] offset:21504
  ds_write_b128 v104, v[244:247] offset:22528
  ds_write_b128 v104, v[248:251] offset:23552
  v_mov_b32 v4, v128
  v_mov_b32 v5, v129
  v_mov_b32 v6, v130
  v_mov_b32 v7, v131
  v_mov_b32 v8, v132
  v_mov_b32 v9, v133
  v_mov_b32 v10, v134
  v_mov_b32 v11, v135
  v_mov_b32 v12, v136
  v_mov_b32 v13, v137
  v_mov_b32 v14, v138
  v_mov_b32 v15, v139
  v_mov_b32 v16, v144
  v_mov_b32 v17, v145
  v_mov_b32 v18, v146
  v_mov_b32 v19, v147
  v_mov_b32 v20, v148
  v_mov_b32 v21, v149
  v_mov_b32 v22, v150
  v_mov_b32 v23, v151
  v_mov_b32 v24, v152
  v_mov_b32 v25, v153
  v_mov_b32 v26, v154
  v_mov_b32 v27, v155
concat_heads__grouped_kv_mqa__linear_kernel_hedgehog__prompt_kernel_own0:
  s_cmp_lg_u32 s3, 1
  s_cbranch_scc1 concat_heads__grouped_kv_mqa__linear_kernel_hedgehog__prompt_kernel_own1
  ds_write_b128 v104, v[128:131] offset:0
  ds_write_b128 v104, v[132:135] offset:1024
  ds_write_b128 v104, v[136:139] offset:2048
  ds_write_b128 v104, v[144:147] offset:3072
  ds_write_b128 v104, v[148:151] offset:4096
  ds_write_b128 v104, v[152:155] offset:5120
  ds_write_b128 v104, v[192:195] offset:12288
  ds_write_b128 v104, v[196:199] offset:13312
  ds_write_b128 v104, v[200:203] offset:14336
  ds_write_b128 v104, v[208:211] offset:15360
  ds_write_b128 v104, v[212:215] offset:16384
  ds_write_b128 v104, v[216:219] offset:17408
  ds_write_b128 v104, v[224:227] offset:18432
  ds_write_b128 v104, v[228:231] offset:19456
  ds_write_b128 v104, v[232:235] offset:20480
  ds_write_b128 v104, v[240:243] offset:21504
  ds_write_b128 v104, v[244:247] offset:22528
  ds_write_b128 v104, v[248:251] offset:23552
  v_mov_b32 v4, v160
  v_mov_b32 v5, v161
  v_mov_b32 v6, v162
  v_mov_b32 v7, v163
  v_mov_b32 v8, v164
  v_mov_b32 v9, v165
  v_mov_b32 v10, v166
  v_mov_b32 v11, v167
  v_mov_b32 v12, v168
  v_mov_b32 v13, v169
  v_mov_b32 v14, v170
  v_mov_b32 v15, v171
  v_mov_b32 v16, v176
  v_mov_b32 v17, v177
  v_mov_b32 v18, v178
  v_mov_b32 v19, v179
  v_mov_b32 v20, v180
  v_mov_b32 v21, v181
  v_mov_b32 v22, v182
  v_mov_b32 v23, v183
  v_mov_b32 v24, v184
  v_mov_b32 v25, v185
  v_mov_b32 v26, v186
  v_mov_b32 v27, v187
concat_heads__grouped_kv_mqa__linear_kernel_hedgehog__prompt_kernel_own1:
  s_cmp_lg_u32 s3, 2
  s_cbranch_scc1 concat_heads__grouped_kv_mqa__linear_kernel_hedgehog__prompt_kernel_own2
  ds_write_b128 v104, v[128:131] offset:0
  ds_write_b128 v104, v[132:135] offset:1024
  ds_write_b128 v104, v[136:139] offset:2048
  ds_write_b128 v104, v[144:147] offset:3072
  ds_write_b128 v104, v[148:151] offset:4096
  ds_write_b128 v104, v[152:155] offset:5120
  ds_write_b128 v104, v[160:163] offset:6144
  ds_write_b128 v104, v[164:167] offset:7168
  ds_write_b128 v104, v[168:171] offset:8192
  ds_write_b128 v104, v[176:179] offset:9216
  ds_write_b128 v104, v[180:183] offset:10240
  ds_write_b128 v104, v[184:187] offset:11264
  ds_write_b128 v104, v[224:227] offset:18432
  ds_write_b128 v104, v[228:231] offset:19456
  ds_write_b128 v104, v[232:235] offset:20480
  ds_write_b128 v104, v[240:243] offset:21504
  ds_write_b128 v104, v[244:247] offset:22528
  ds_write_b128 v104, v[248:251] offset:23552
  v_mov_b32 v4, v192
  v_mov_b32 v5, v193
  v_mov_b32 v6, v194
  v_mov_b32 v7, v195
  v_mov_b32 v8, v196
  v_mov_b32 v9, v197
  v_mov_b32 v10, v198
  v_mov_b32 v11, v199
  v_mov_b32 v12, v200
  v_mov_b32 v13, v201
  v_mov_b32 v14, v202
  v_mov_b32 v15, v203
  v_mov_b32 v16, v208
  v_mov_b32 v17, v209
  v_mov_b32 v18, v210
  v_mov_b32 v19, v211
  v_mov_b32 v20, v212
  v_mov_b32 v21, v213
  v_mov_b32 v22, v214
  v_mov_b32 v23, v215
  v_mov_b32 v24, v216
  v_mov_b32 v25, v217
  v_mov_b32 v26, v218
  v_mov_b32 v27, v219
concat_heads__grouped_kv_mqa__linear_kernel_hedgehog__prompt_kernel_own2:
  s_cmp_lg_u32 s3, 3
  s_cbranch_scc1 concat_heads__grouped_kv_mqa__linear_kernel_hedgehog__prompt_kernel_own3
  ds_write_b128 v104, v[128:131] offset:0
  ds_write_b128 v104, v[132:135] offset:1024
  ds_write_b128 v104, v[136:139] offset:2048
  ds_write_b128 v104, v[144:147] offset:3072
  ds_write_b128 v104, v[148:151] offset:4096
  ds_write_b128 v104, v[152:155] offset:5120
  ds_write_b128 v104, v[160:163] offset:6144
  ds_write_b128 v104, v[164:167] offset:7168
  ds_write_b128 v104, v[168:171] offset:8192
  ds_write_b128 v104, v[176:179] offset:9216
  ds_write_b128 v104, v[180:183] offset:10240
  ds_write_b128 v104, v[184:187] offset:11264
  ds_write_b128 v104, v[192:195] offset:12288
  ds_write_b128 v104, v[196:199] offset:13312
  ds_write_b128 v104, v[200:203] offset:14336
  ds_write_b128 v104, v[208:211] offset:15360
  ds_write_b128 v104, v[212:215] offset:16384
  ds_write_b128 v104, v[216:219] offset:17408
  v_mov_b32 v4, v224
  v_mov_b32 v5, v225
  v_mov_b32 v6, v226
  v_mov_b32 v7, v227
  v_mov_b32 v8, v228
  v_mov_b32 v9, v229
  v_mov_b32 v10, v230
  v_mov_b32 v11, v231
  v_mov_b32 v12, v232
  v_mov_b32 v13, v233
  v_mov_b32 v14, v234
  v_mov_b32 v15, v235
  v_mov_b32 v16, v240
  v_mov_b32 v17, v241
  v_mov_b32 v18, v242
  v_mov_b32 v19, v243
  v_mov_b32 v20, v244
  v_mov_b32 v21, v245
  v_mov_b32 v22, v246
  v_mov_b32 v23, v247
  v_mov_b32 v24, v248
  v_mov_b32 v25, v249
  v_mov_b32 v26, v250
  v_mov_b32 v27, v251
concat_heads__grouped_kv_mqa__linear_kernel_hedgehog__prompt_kernel_own3:
  s_add_u32 s27, s3, 1
  s_and_b32 s27, s27, 3
  s_mul_i32 s27, s27, 28672
  s_mul_i32 s28, s3, 6144
  s_add_u32 s27, s27, s28
  v_add_u32 v105, s27, v120
  s_add_u32 s27, s3, 2
  s_and_b32 s27, s27, 3
  s_mul_i32 s27, s27, 28672
  s_mul_i32 s28, s3, 6144
  s_add_u32 s27, s27, s28
  v_add_u32 v106, s27, v120
  s_add_u32 s27, s3, 3
  s_and_b32 s27, s27, 3
  s_mul_i32 s27, s27, 28672
  s_mul_i32 s28, s3, 6144
  s_add_u32 s27, s27, s28
  v_add_u32 v107, s27, v120
  v_and_b32 v3, 31, v2
  v_lshrrev_b32 v119, 5, v2
  v_mul_u32_u24 v3, 320, v3
  v_lshl_add_u32 v3, v119, 3, v3
  s_mul_i32 s27, s3, 80
  s_add_u32 s27, s27, 114688
  v_add_u32 v108, s27, v3
  s_waitcnt lgkmcnt(0)
  s_barrier
  ds_read_b128 v[28:31], v105 offset:0
  ds_read_b128 v[32:35], v105 offset:1024
  ds_read_b128 v[36:39], v105 offset:2048
  ds_read_b128 v[40:43], v105 offset:3072
  ds_read_b128 v[44:47], v105 offset:4096
  ds_read_b128 v[48:51], v105 offset:5120
  ds_read_b128 v[52:55], v106 offset:0
  ds_read_b128 v[56:59], v106 offset:1024
  ds_read_b128 v[60:63], v106 offset:2048
  ds_read_b128 v[64:67], v106 offset:3072
  ds_read_b128 v[68:71], v106 offset:4096
  ds_read_b128 v[72:75], v106 offset:5120
  ds_read_b128 v[76:79], v107 offset:0
  ds_read_b128 v[80:83], v107 offset:1024
  ds_read_b128 v[84:87], v107 offset:2048
  ds_read_b128 v[88:91], v107 offset:3072
  ds_read_b128 v[92:95], v107 offset:4096
  ds_read_b128 v[96:99], v107 offset:5120
  s_waitcnt lgkmcnt(12)
  v_add_f32 v4, v4, v28
  v_add_f32 v5, v5, v29
  v_add_f32 v6, v6, v30
  v_add_f32 v7, v7, v31
  v_add_f32 v8, v8, v32
  v_add_f32 v9, v9, v33
  v_add_f32 v10, v10, v34
  v_add_f32 v11, v11, v35
  v_add_f32 v12, v12, v36
  v_add_f32 v13, v13, v37
  v_add_f32 v14, v14, v38
  v_add_f32 v15, v15, v39
  v_add_f32 v16, v16, v40
  v_add_f32 v17, v17, v41
  v_add_f32 v18, v18, v42
  v_add_f32 v19, v19, v43
  v_add_f32 v20, v20, v44
  v_add_f32 v21, v21, v45
  v_add_f32 v22, v22, v46
  v_add_f32 v23, v23, v47
  v_add_f32 v24, v24, v48
  v_add_f32 v25, v25, v49
  v_add_f32 v26, v26, v50
  v_add_f32 v27, v27, v51
  s_waitcnt lgkmcnt(6)
  v_add_f32 v4, v4, v52
  v_add_f32 v5, v5, v53
  v_add_f32 v6, v6, v54
  v_add_f32 v7, v7, v55
  v_add_f32 v8, v8, v56
  v_add_f32 v9, v9, v57
  v_add_f32 v10, v10, v58
  v_add_f32 v11, v11, v59
  v_add_f32 v12, v12, v60
  v_add_f32 v13, v13, v61
  v_add_f32 v14, v14, v62
  v_add_f32 v15, v15, v63
  v_add_f32 v16, v16, v64
  v_add_f32 v17, v17, v65
  v_add_f32 v18, v18, v66
  v_add_f32 v19, v19, v67
  v_add_f32 v20, v20, v68
  v_add_f32 v21, v21, v69
  v_add_f32 v22, v22, v70
  v_add_f32 v23, v23, v71
  v_add_f32 v24, v24, v72
  v_add_f32 v25, v25, v73
  v_add_f32 v26, v26, v74
  v_add_f32 v27, v27, v75
  s_waitcnt lgkmcnt(0)
  v_add_f32 v4, v4, v76
  v_add_f32 v5, v5, v77
  v_add_f32 v6, v6, v78
  v_add_f32 v7, v7, v79
  v_add_f32 v8, v8, v80
  v_add_f32 v9, v9, v81
  v_add_f32 v10, v10, v82
  v_add_f32 v11, v11, v83
  v_add_f32 v12, v12, v84
  v_add_f32 v13, v13, v85
  v_add_f32 v14, v14, v86
  v_add_f32 v15, v15, v87
  v_add_f32 v16, v16, v88
  v_add_f32 v17, v17, v89
  v_add_f32 v18, v18, v90
  v_add_f32 v19, v19, v91
  v_add_f32 v20, v20, v92
  v_add_f32 v21, v21, v93
  v_add_f32 v22, v22, v94
  v_add_f32 v23, v23, v95
  v_add_f32 v24, v24, v96
  v_add_f32 v25, v25, v97
  v_add_f32 v26, v26, v98
  v_add_f32 v27, v27, v99
  v_mov_b32 v110, v12
  v_mov_b32 v111, v12
  v_mov_b32 v112, v24
  v_mov_b32 v113, v24
  s_nop 1
  v_permlane32_swap_b32 v110, v111
  v_permlane32_swap_b32 v112, v113
  s_nop 1
  s_mov_b32 s27, 0x1f800000
  v_cmp_nle_f32 vcc, s27, v111
  v_cmp_nle_f32 s[28:29], s27, v113
  s_nop 1
  s_or_b64 s[28:29], s[28:29], vcc
  s_cmp_lg_u64 s[28:29], 0
  s_cselect_b32 s27, 1, 0
  s_cmp_eq_u32 s101, 0
  s_cselect_b32 s27, s27, 0
  s_lshl_b32 s28, s3, 2
  s_add_u32 s28, s28, 124928
  v_mov_b32 v114, s28
  v_mov_b32 v115, s27
  ds_write_b32 v114, v115
  v_rcp_f32 v110, v111
  v_rcp_f32 v112, v113
  s_nop 0
  v_mul_f32 v4, v4, v110
  v_mul_f32 v5, v5, v110
  v_mul_f32 v6, v6, v110
  v_mul_f32 v7, v7, v110
  v_mul_f32 v8, v8, v110
  v_mul_f32 v9, v9, v110
  v_mul_f32 v10, v10, v110
  v_mul_f32 v11, v11, v110
  v_mul_f32 v12, v12, v110
  v_mul_f32 v13, v13, v110
  v_mul_f32 v14, v14, v110
  v_mul_f32 v15, v15, v110
  v_cvt_pk_bf16_f32 v28, v4, v5
  v_cvt_pk_bf16_f32 v29, v6, v7
  v_cvt_pk_bf16_f32 v30, v8, v9
  v_cvt_pk_bf16_f32 v31, v10, v11
  v_cvt_pk_bf16_f32 v32, v12, v13
  v_cvt_pk_bf16_f32 v33, v14, v15
  ds_write_b64 v108, v[28:29] offset:0
  ds_write_b64 v108, v[30:31] offset:16
  v_mul_f32 v16, v16, v112
  v_mul_f32 v17, v17, v112
  v_mul_f32 v18, v18, v112
  v_mul_f32 v19, v19, v112
  v_mul_f32 v20, v20, v112
  v_mul_f32 v21, v21, v112
  v_mul_f32 v22, v22, v112
  v_mul_f32 v23, v23, v112
  v_mul_f32 v24, v24, v112
  v_mul_f32 v25, v25, v112
  v_mul_f32 v26, v26, v112
  v_mul_f32 v27, v27, v112
  v_cvt_pk_bf16_f32 v34, v16, v17
  v_cvt_pk_bf16_f32 v35, v18, v19
  v_cvt_pk_bf16_f32 v36, v20, v21
  v_cvt_pk_bf16_f32 v37, v22, v23
  v_cvt_pk_bf16_f32 v38, v24, v25
  v_cvt_pk_bf16_f32 v39, v26, v27
  ds_write_b64 v108, v[34:35] offset:40
  ds_write_b64 v108, v[36:37] offset:56
  s_mov_b64 exec, s[38:39]
  ds_write_b64 v108, v[32:33] offset:32
  ds_write_b64 v108, v[38:39] offset:72
  s_mov_b64 exec, -1
  s_lshr_b32 s12, s2, 2
  s_mul_i32 s12, s12, 40960
  s_and_b32 s13, s2, 3
  s_mul_i32 s13, s13, 320
  s_add_u32 s12, s12, s13
  s_add_u32 s12, s12, 4194304
  s_mul_i32 s27, s3, 192
  s_add_u32 s27, s27, 0
  v_add_u32 v110, s27, v2
  v_mul_u32_u24 v112, 3277, v110
  v_lshrrev_b32 v112, 16, v112
  v_mul_u32_u24 v111, 20, v112
  v_sub_u32 v111, v110, v111
  v_mul_u32_u24 v112, 1280, v112
  v_lshl_add_u32 v112, v111, 4, v112
  v_lshlrev_b32 v111, 4, v110
  v_add_u32 v111, 114688, v111
  v_cmp_gt_u32 vcc, 640, v110
  v_mov_b32 v3, 0x7f000000
  s_nop 0
  v_cndmask_b32 v112, v3, v112, vcc
  s_mul_i32 s27, s3, 192
  s_add_u32 s27, s27, 64
  v_add_u32 v113, s27, v2
  v_mul_u32_u24 v115, 3277, v113
  v_lshrrev_b32 v115, 16, v115
  v_mul_u32_u24 v114, 20, v115
  v_sub_u32 v114, v113, v114
  v_mul_u32_u24 v115, 1280, v115
  v_lshl_add_u32 v115, v114, 4, v115
  v_lshlrev_b32 v114, 4, v113
  v_add_u32 v114, 114688, v114
  v_cmp_gt_u32 vcc, 640, v113
  v_mov_b32 v3, 0x7f000000
  s_nop 0
  v_cndmask_b32 v115, v3, v115, vcc
  s_mul_i32 s27, s3, 192
  s_add_u32 s27, s27, 128
  v_add_u32 v116, s27, v2
  v_mul_u32_u24 v118, 3277, v116
  v_lshrrev_b32 v118, 16, v118
  v_mul_u32_u24 v117, 20, v118
  v_sub_u32 v117, v116, v117
  v_mul_u32_u24 v118, 1280, v118
  v_lshl_add_u32 v118, v117, 4, v118
  v_lshlrev_b32 v117, 4, v116
  v_add_u32 v117, 114688, v117
  v_cmp_gt_u32 vcc, 640, v116
  v_mov_b32 v3, 0x7f000000
  s_nop 0
  v_cndmask_b32 v118, v3, v118, vcc
  v_mov_b32 v119, 124928
  s_waitcnt lgkmcnt(0)
  s_barrier
  ds_read_b128 v[100:103], v119
  ds_read_b128 v[28:31], v111
  ds_read_b128 v[32:35], v114
  ds_read_b128 v[36:39], v117
  s_waitcnt lgkmcnt(3)
  v_or3_b32 v100, v100, v101, v102
  v_or_b32 v100, v100, v103
  s_nop 1
  v_readfirstlane_b32 s26, v100
  s_cmp_lg_u32 s26, 0
  s_cbranch_scc1 concat_heads__grouped_kv_mqa__linear_kernel_hedgehog__prompt_kernel_fb
  s_waitcnt lgkmcnt(0)
  buffer_store_dwordx4 v[28:31], v112, s[8:11], s12 offen sc0 sc1
  buffer_store_dwordx4 v[32:35], v115, s[8:11], s12 offen sc0 sc1
  buffer_store_dwordx4 v[36:39], v118, s[8:11], s12 offen sc0 sc1
  s_waitcnt vmcnt(0)
  s_barrier
  s_mov_b32 s3, s100
  s_and_b32 s40, s2, 1
  s_lshr_b32 s41, s2, 1
  s_and_b32 s41, s41, 3
  s_lshl_b32 s41, s41, 2
  s_lshr_b32 s42, s2, 3
  s_and_b32 s43, s42, 3
  s_add_u32 s41, s41, s43
  s_lshr_b32 s42, s42, 2
  s_movk_i32 s44, 1280
  s_and_b32 s49, s3, 1
  s_lshl_b32 s50, s49, 14
  s_lshr_b32 s51, s3, 1
  s_lshl_b32 s51, s51, 13
  s_add_u32 s50, s50, s51
  s_mul_i32 s51, s49, 10240
  s_add_u32 s51, s51, 32768
  v_and_b32 v174, 15, v1
  v_lshrrev_b32 v175, 4, v1
  v_and_b32 v176, 7, v174
  v_xor_b32 v176, v176, v175
  v_lshlrev_b32 v176, 4, v176
  v_lshl_add_u32 v176, v174, 7, v176
  v_add_u32 v168, s50, v176
  v_xor_b32 v169, 64, v168
  v_lshrrev_b32 v177, 1, v175
  v_lshlrev_b32 v177, 4, v177
  v_and_b32 v178, 1, v175
  v_lshl_add_u32 v177, v178, 2, v177
  v_lshrrev_b32 v178, 2, v174
  v_add_u32 v177, v177, v178
  v_mul_u32_u24 v177, 160, v177
  v_and_b32 v178, 3, v1
  v_mul_u32_u24 v178, 40, v178
  v_add_u32 v177, v177, v178
  v_add_u32 v170, s51, v177
  s_barrier
  v_mov_b32 v16, 0
  v_mov_b32 v17, 0
  v_mov_b32 v18, 0
  v_mov_b32 v19, 0
  v_mov_b32 v20, 0
  v_mov_b32 v21, 0
  v_mov_b32 v22, 0
  v_mov_b32 v23, 0
  v_mov_b32 v24, 0
  v_mov_b32 v25, 0
  v_mov_b32 v26, 0
  v_mov_b32 v27, 0
  v_mov_b32 v28, 0
  v_mov_b32 v29, 0
  v_mov_b32 v30, 0
  v_mov_b32 v31, 0
  v_mov_b32 v32, 0
  v_mov_b32 v33, 0
  v_mov_b32 v34, 0
  v_mov_b32 v35, 0
  v_mov_b32 v36, 0
  v_mov_b32 v37, 0
  v_mov_b32 v38, 0
  v_mov_b32 v39, 0
  v_mov_b32 v40, 0
  v_mov_b32 v41, 0
  v_mov_b32 v42, 0
  v_mov_b32 v43, 0
  v_mov_b32 v44, 0
  v_mov_b32 v45, 0
  v_mov_b32 v46, 0
  v_mov_b32 v47, 0
  v_mov_b32 v48, 0
  v_mov_b32 v49, 0
  v_mov_b32 v50, 0
  v_mov_b32 v51, 0
  v_mov_b32 v52, 0
  v_mov_b32 v53, 0
  v_mov_b32 v54, 0
  v_mov_b32 v55, 0
  v_mov_b32 v56, 0
  v_mov_b32 v57, 0
  v_mov_b32 v58, 0
  v_mov_b32 v59, 0
  v_mov_b32 v60, 0
  v_mov_b32 v61, 0
  v_mov_b32 v62, 0
  v_mov_b32 v63, 0
  v_mov_b32 v64, 0
  v_mov_b32 v65, 0
  v_mov_b32 v66, 0
  v_mov_b32 v67, 0
  v_mov_b32 v68, 0
  v_mov_b32 v69, 0
  v_mov_b32 v70, 0
  v_mov_b32 v71, 0
  v_mov_b32 v72, 0
  v_mov_b32 v73, 0
  v_mov_b32 v74, 0
  v_mov_b32 v75, 0
  v_mov_b32 v76, 0
  v_mov_b32 v77, 0
  v_mov_b32 v78, 0
  v_mov_b32 v79, 0
  v_mov_b32 v80, 0
  v_mov_b32 v81, 0
  v_mov_b32 v82, 0
  v_mov_b32 v83, 0
  v_mov_b32 v84, 0
  v_mov_b32 v85, 0
  v_mov_b32 v86, 0
  v_mov_b32 v87, 0
  v_mov_b32 v88, 0
  v_mov_b32 v89, 0
  v_mov_b32 v90, 0
  v_mov_b32 v91, 0
  v_mov_b32 v92, 0
  v_mov_b32 v93, 0
  v_mov_b32 v94, 0
  v_mov_b32 v95, 0
  s_mov_b32 s26, 0
  v_add_u32 v171, s26, v168
  v_add_u32 v172, s26, v169
  v_add_u32 v173, s26, v170
  s_mov_b32 s27, 5
  s_barrier
  ds_read_b128 v[96:99], v171 offset:0
  ds_read_b128 v[100:103], v171 offset:2048
  ds_read_b128 v[104:107], v171 offset:4096
  ds_read_b128 v[108:111], v171 offset:6144
  ds_read_b64_tr_b16 v[128:129], v173 offset:0
  ds_read_b64_tr_b16 v[130:131], v173 offset:1280
  ds_read_b64_tr_b16 v[132:133], v173 offset:8
  ds_read_b64_tr_b16 v[134:135], v173 offset:1288
  ds_read_b64_tr_b16 v[136:137], v173 offset:16
  ds_read_b64_tr_b16 v[138:139], v173 offset:1296
  ds_read_b64_tr_b16 v[140:141], v173 offset:24
  ds_read_b64_tr_b16 v[142:143], v173 offset:1304
  ds_read_b64_tr_b16 v[144:145], v173 offset:32
  ds_read_b64_tr_b16 v[146:147], v173 offset:1312
  .p2align 6
concat_heads__grouped_kv_mqa__linear_kernel_hedgehog__prompt_kernel_p3_kloop:
  s_waitcnt lgkmcnt(0)
  v_mfma_f32_16x16x32_bf16 v[16:19], v[128:131], v[96:99], v[16:19]
  ds_read_b128 v[112:115], v172 offset:0
  v_mfma_f32_16x16x32_bf16 v[20:23], v[128:131], v[100:103], v[20:23]
  ds_read_b128 v[116:119], v172 offset:2048
  v_mfma_f32_16x16x32_bf16 v[24:27], v[128:131], v[104:107], v[24:27]
  ds_read_b128 v[120:123], v172 offset:4096
  v_mfma_f32_16x16x32_bf16 v[28:31], v[128:131], v[108:111], v[28:31]
  ds_read_b128 v[124:127], v172 offset:6144
  v_mfma_f32_16x16x32_bf16 v[32:35], v[132:135], v[96:99], v[32:35]
  ds_read_b64_tr_b16 v[148:149], v173 offset:5120
  v_mfma_f32_16x16x32_bf16 v[36:39], v[132:135], v[100:103], v[36:39]
  ds_read_b64_tr_b16 v[150:151], v173 offset:6400
  v_mfma_f32_16x16x32_bf16 v[40:43], v[132:135], v[104:107], v[40:43]
  ds_read_b64_tr_b16 v[152:153], v173 offset:5128
  v_mfma_f32_16x16x32_bf16 v[44:47], v[132:135], v[108:111], v[44:47]
  ds_read_b64_tr_b16 v[154:155], v173 offset:6408
  v_mfma_f32_16x16x32_bf16 v[48:51], v[136:139], v[96:99], v[48:51]
  ds_read_b64_tr_b16 v[156:157], v173 offset:5136
  v_mfma_f32_16x16x32_bf16 v[52:55], v[136:139], v[100:103], v[52:55]
  ds_read_b64_tr_b16 v[158:159], v173 offset:6416
  v_mfma_f32_16x16x32_bf16 v[56:59], v[136:139], v[104:107], v[56:59]
  ds_read_b64_tr_b16 v[160:161], v173 offset:5144
  v_mfma_f32_16x16x32_bf16 v[60:63], v[136:139], v[108:111], v[60:63]
  ds_read_b64_tr_b16 v[162:163], v173 offset:6424
  v_mfma_f32_16x16x32_bf16 v[64:67], v[140:143], v[96:99], v[64:67]
  ds_read_b64_tr_b16 v[164:165], v173 offset:5152
  v_mfma_f32_16x16x32_bf16 v[68:71], v[140:143], v[100:103], v[68:71]
  ds_read_b64_tr_b16 v[166:167], v173 offset:6432
  v_mfma_f32_16x16x32_bf16 v[72:75], v[140:143], v[104:107], v[72:75]
  v_mfma_f32_16x16x32_bf16 v[76:79], v[140:143], v[108:111], v[76:79]
  v_mfma_f32_16x16x32_bf16 v[80:83], v[144:147], v[96:99], v[80:83]
  v_mfma_f32_16x16x32_bf16 v[84:87], v[144:147], v[100:103], v[84:87]
  v_mfma_f32_16x16x32_bf16 v[88:91], v[144:147], v[104:107], v[88:91]
  v_mfma_f32_16x16x32_bf16 v[92:95], v[144:147], v[108:111], v[92:95]
  s_waitcnt lgkmcnt(0)
  s_barrier
  v_mfma_f32_16x16x32_bf16 v[16:19], v[148:151], v[112:115], v[16:19]
  s_add_u32 s26, s26, 53248
  s_cmp_ge_u32 s26, 159744
  v_mfma_f32_16x16x32_bf16 v[20:23], v[148:151], v[116:119], v[20:23]
  s_cselect_b32 s26, 0, s26
  v_mfma_f32_16x16x32_bf16 v[24:27], v[148:151], v[120:123], v[24:27]
  v_add_u32 v171, s26, v168
  v_mfma_f32_16x16x32_bf16 v[28:31], v[148:151], v[124:127], v[28:31]
  v_add_u32 v172, s26, v169
  v_mfma_f32_16x16x32_bf16 v[32:35], v[152:155], v[112:115], v[32:35]
  v_add_u32 v173, s26, v170
  v_mfma_f32_16x16x32_bf16 v[36:39], v[152:155], v[116:119], v[36:39]
  ds_read_b128 v[96:99], v171 offset:0
  v_mfma_f32_16x16x32_bf16 v[40:43], v[152:155], v[120:123], v[40:43]
  ds_read_b128 v[100:103], v171 offset:2048
  v_mfma_f32_16x16x32_bf16 v[44:47], v[152:155], v[124:127], v[44:47]
  ds_read_b128 v[104:107], v171 offset:4096
  v_mfma_f32_16x16x32_bf16 v[48:51], v[156:159], v[112:115], v[48:51]
  ds_read_b128 v[108:111], v171 offset:6144
  v_mfma_f32_16x16x32_bf16 v[52:55], v[156:159], v[116:119], v[52:55]
  ds_read_b64_tr_b16 v[128:129], v173 offset:0
  v_mfma_f32_16x16x32_bf16 v[56:59], v[156:159], v[120:123], v[56:59]
  ds_read_b64_tr_b16 v[130:131], v173 offset:1280
  v_mfma_f32_16x16x32_bf16 v[60:63], v[156:159], v[124:127], v[60:63]
  ds_read_b64_tr_b16 v[132:133], v173 offset:8
  v_mfma_f32_16x16x32_bf16 v[64:67], v[160:163], v[112:115], v[64:67]
  ds_read_b64_tr_b16 v[134:135], v173 offset:1288
  v_mfma_f32_16x16x32_bf16 v[68:71], v[160:163], v[116:119], v[68:71]
  ds_read_b64_tr_b16 v[136:137], v173 offset:16
  v_mfma_f32_16x16x32_bf16 v[72:75], v[160:163], v[120:123], v[72:75]
  ds_read_b64_tr_b16 v[138:139], v173 offset:1296
  v_mfma_f32_16x16x32_bf16 v[76:79], v[160:163], v[124:127], v[76:79]
  ds_read_b64_tr_b16 v[140:141], v173 offset:24
  v_mfma_f32_16x16x32_bf16 v[80:83], v[164:167], v[112:115], v[80:83]
  ds_read_b64_tr_b16 v[142:143], v173 offset:1304
  v_mfma_f32_16x16x32_bf16 v[84:87], v[164:167], v[116:119], v[84:87]
  ds_read_b64_tr_b16 v[144:145], v173 offset:32
  v_mfma_f32_16x16x32_bf16 v[88:91], v[164:167], v[120:123], v[88:91]
  ds_read_b64_tr_b16 v[146:147], v173 offset:1312
  v_mfma_f32_16x16x32_bf16 v[92:95], v[164:167], v[124:127], v[92:95]
  s_sub_u32 s27, s27, 1
  s_cmp_lg_u32 s27, 0
  s_cbranch_scc1 concat_heads__grouped_kv_mqa__linear_kernel_hedgehog__prompt_kernel_p3_kloop
  s_waitcnt lgkmcnt(0)
  s_barrier
  s_waitcnt lgkmcnt(0)
  v_lshlrev_b32 v174, 4, v1
  s_mul_i32 s52, s3, 10240
  v_add_u32 v175, s52, v174
  s_xor_b32 s53, s3, 1
  s_mul_i32 s53, s53, 10240
  v_add_u32 v176, s53, v174
  s_cmp_eq_u32 s49, 0
  s_cbranch_scc0 concat_heads__grouped_kv_mqa__linear_kernel_hedgehog__prompt_kernel_k1
  ds_write_b128 v175, v[24:27] offset:0
  ds_write_b128 v175, v[40:43] offset:1024
  ds_write_b128 v175, v[56:59] offset:2048
  ds_write_b128 v175, v[72:75] offset:3072
  ds_write_b128 v175, v[88:91] offset:4096
  ds_write_b128 v175, v[28:31] offset:5120
  ds_write_b128 v175, v[44:47] offset:6144
  ds_write_b128 v175, v[60:63] offset:7168
  ds_write_b128 v175, v[76:79] offset:8192
  ds_write_b128 v175, v[92:95] offset:9216
  v_mov_b32 v96, v16
  v_mov_b32 v97, v17
  v_mov_b32 v98, v18
  v_mov_b32 v99, v19
  v_mov_b32 v100, v32
  v_mov_b32 v101, v33
  v_mov_b32 v102, v34
  v_mov_b32 v103, v35
  v_mov_b32 v104, v48
  v_mov_b32 v105, v49
  v_mov_b32 v106, v50
  v_mov_b32 v107, v51
  v_mov_b32 v108, v64
  v_mov_b32 v109, v65
  v_mov_b32 v110, v66
  v_mov_b32 v111, v67
  v_mov_b32 v112, v80
  v_mov_b32 v113, v81
  v_mov_b32 v114, v82
  v_mov_b32 v115, v83
  v_mov_b32 v116, v20
  v_mov_b32 v117, v21
  v_mov_b32 v118, v22
  v_mov_b32 v119, v23
  v_mov_b32 v120, v36
  v_mov_b32 v121, v37
  v_mov_b32 v122, v38
  v_mov_b32 v123, v39
  v_mov_b32 v124, v52
  v_mov_b32 v125, v53
  v_mov_b32 v126, v54
  v_mov_b32 v127, v55
  v_mov_b32 v128, v68
  v_mov_b32 v129, v69
  v_mov_b32 v130, v70
  v_mov_b32 v131, v71
  v_mov_b32 v132, v84
  v_mov_b32 v133, v85
  v_mov_b32 v134, v86
  v_mov_b32 v135, v87
  s_branch concat_heads__grouped_kv_mqa__linear_kernel_hedgehog__prompt_kernel_kj
concat_heads__grouped_kv_mqa__linear_kernel_hedgehog__prompt_kernel_k1:
  ds_write_b128 v175, v[16:19] offset:0
  ds_write_b128 v175, v[32:35] offset:1024
  ds_write_b128 v175, v[48:51] offset:2048
  ds_write_b128 v175, v[64:67] offset:3072
  ds_write_b128 v175, v[80:83] offset:4096
  ds_write_b128 v175, v[20:23] offset:5120
  ds_write_b128 v175, v[36:39] offset:6144
  ds_write_b128 v175, v[52:55] offset:7168
  ds_write_b128 v175, v[68:71] offset:8192
  ds_write_b128 v175, v[84:87] offset:9216
  v_mov_b32 v96, v24
  v_mov_b32 v97, v25
  v_mov_b32 v98, v26
  v_mov_b32 v99, v27
  v_mov_b32 v100, v40
  v_mov_b32 v101, v41
  v_mov_b32 v102, v42
  v_mov_b32 v103, v43
  v_mov_b32 v104, v56
  v_mov_b32 v105, v57
  v_mov_b32 v106, v58
  v_mov_b32 v107, v59
  v_mov_b32 v108, v72
  v_mov_b32 v109, v73
  v_mov_b32 v110, v74
  v_mov_b32 v111, v75
  v_mov_b32 v112, v88
  v_mov_b32 v113, v89
  v_mov_b32 v114, v90
  v_mov_b32 v115, v91
  v_mov_b32 v116, v28
  v_mov_b32 v117, v29
  v_mov_b32 v118, v30
  v_mov_b32 v119, v31
  v_mov_b32 v120, v44
  v_mov_b32 v121, v45
  v_mov_b32 v122, v46
  v_mov_b32 v123, v47
  v_mov_b32 v124, v60
  v_mov_b32 v125, v61
  v_mov_b32 v126, v62
  v_mov_b32 v127, v63
  v_mov_b32 v128, v76
  v_mov_b32 v129, v77
  v_mov_b32 v130, v78
  v_mov_b32 v131, v79
  v_mov_b32 v132, v92
  v_mov_b32 v133, v93
  v_mov_b32 v134, v94
  v_mov_b32 v135, v95
concat_heads__grouped_kv_mqa__linear_kernel_hedgehog__prompt_kernel_kj:
  s_waitcnt lgkmcnt(0)
  s_barrier
  ds_read_b128 v[16:19], v176 offset:0
  ds_read_b128 v[20:23], v176 offset:1024
  ds_read_b128 v[24:27], v176 offset:2048
  ds_read_b128 v[28:31], v176 offset:3072
  ds_read_b128 v[32:35], v176 offset:4096
  ds_read_b128 v[36:39], v176 offset:5120
  ds_read_b128 v[40:43], v176 offset:6144
  ds_read_b128 v[44:47], v176 offset:7168
  ds_read_b128 v[48:51], v176 offset:8192
  ds_read_b128 v[52:55], v176 offset:9216
  v_and_b32 v177, 15, v1
  v_mul_u32_u24 v177, 160, v177
  v_lshrrev_b32 v178, 4, v1
  v_mul_u32_u24 v178, 40, v178
  s_mul_i32 s52, s3, 5120
  s_add_u32 s52, s52, 40960
  v_add3_u32 v177, v177, v178, s52
  s_waitcnt lgkmcnt(0)
  v_add_f32 v96, v96, v16
  v_add_f32 v97, v97, v17
  v_add_f32 v98, v98, v18
  v_add_f32 v99, v99, v19
  v_add_f32 v100, v100, v20
  v_add_f32 v101, v101, v21
  v_add_f32 v102, v102, v22
  v_add_f32 v103, v103, v23
  v_add_f32 v104, v104, v24
  v_add_f32 v105, v105, v25
  v_add_f32 v106, v106, v26
  v_add_f32 v107, v107, v27
  v_add_f32 v108, v108, v28
  v_add_f32 v109, v109, v29
  v_add_f32 v110, v110, v30
  v_add_f32 v111, v111, v31
  v_add_f32 v112, v112, v32
  v_add_f32 v113, v113, v33
  v_add_f32 v114, v114, v34
  v_add_f32 v115, v115, v35
  v_add_f32 v116, v116, v36
  v_add_f32 v117, v117, v37
  v_add_f32 v118, v118, v38
  v_add_f32 v119, v119, v39
  v_add_f32 v120, v120, v40
  v_add_f32 v121, v121, v41
  v_add_f32 v122, v122, v42
  v_add_f32 v123, v123, v43
  v_add_f32 v124, v124, v44
  v_add_f32 v125, v125, v45
  v_add_f32 v126, v126, v46
  v_add_f32 v127, v127, v47
  v_add_f32 v128, v128, v48
  v_add_f32 v129, v129, v49
  v_add_f32 v130, v130, v50
  v_add_f32 v131, v131, v51
  v_add_f32 v132, v132, v52
  v_add_f32 v133, v133, v53
  v_add_f32 v134, v134, v54
  v_add_f32 v135, v135, v55
  v_cvt_pk_bf16_f32 v56, v96, v97
  v_cvt_pk_bf16_f32 v57, v98, v99
  v_cvt_pk_bf16_f32 v58, v100, v101
  v_cvt_pk_bf16_f32 v59, v102, v103
  v_cvt_pk_bf16_f32 v60, v104, v105
  v_cvt_pk_bf16_f32 v61, v106, v107
  v_cvt_pk_bf16_f32 v62, v108, v109
  v_cvt_pk_bf16_f32 v63, v110, v111
  v_cvt_pk_bf16_f32 v64, v112, v113
  v_cvt_pk_bf16_f32 v65, v114, v115
  ds_write_b64 v177, v[56:57] offset:0
  ds_write_b64 v177, v[58:59] offset:8
  ds_write_b64 v177, v[60:61] offset:16
  ds_write_b64 v177, v[62:63] offset:24
  ds_write_b64 v177, v[64:65] offset:32
  v_cvt_pk_bf16_f32 v66, v116, v117
  v_cvt_pk_bf16_f32 v67, v118, v119
  v_cvt_pk_bf16_f32 v68, v120, v121
  v_cvt_pk_bf16_f32 v69, v122, v123
  v_cvt_pk_bf16_f32 v70, v124, v125
  v_cvt_pk_bf16_f32 v71, v126, v127
  v_cvt_pk_bf16_f32 v72, v128, v129
  v_cvt_pk_bf16_f32 v73, v130, v131
  v_cvt_pk_bf16_f32 v74, v132, v133
  v_cvt_pk_bf16_f32 v75, v134, v135
  ds_write_b64 v177, v[66:67] offset:2560
  ds_write_b64 v177, v[68:69] offset:2568
  ds_write_b64 v177, v[70:71] offset:2576
  ds_write_b64 v177, v[72:73] offset:2584
  ds_write_b64 v177, v[74:75] offset:2592
  s_mov_b32 s16, s90
  s_and_b32 s17, s91, 0xffff
  s_mov_b32 s18, 5242880
  s_mov_b32 s19, 0x00020000
  s_lshl_b32 s53, s41, 7
  s_lshr_b32 s54, s3, 1
  s_lshl_b32 s54, s54, 6
  s_add_u32 s53, s53, s54
  s_lshl_b32 s54, s49, 5
  s_add_u32 s53, s53, s54
  s_mul_i32 s53, s53, 2560
  s_mul_i32 s54, s40, 1280
  s_add_u32 s53, s53, s54
  s_mul_i32 s54, s42, 160
  s_add_u32 s53, s53, s54
  v_add_u32 v76, 0, v1
  v_mul_u32_u24 v77, 6554, v76
  v_lshrrev_b32 v77, 16, v77
  v_mul_u32_u24 v178, 10, v77
  v_sub_u32 v178, v76, v178
  v_mul_u32_u24 v77, 2560, v77
  v_lshl_add_u32 v77, v178, 4, v77
  v_lshlrev_b32 v76, 4, v76
  v_add_u32 v76, s52, v76
  v_add_u32 v78, 64, v1
  v_mul_u32_u24 v79, 6554, v78
  v_lshrrev_b32 v79, 16, v79
  v_mul_u32_u24 v178, 10, v79
  v_sub_u32 v178, v78, v178
  v_mul_u32_u24 v79, 2560, v79
  v_lshl_add_u32 v79, v178, 4, v79
  v_lshlrev_b32 v78, 4, v78
  v_add_u32 v78, s52, v78
  v_add_u32 v80, 128, v1
  v_mul_u32_u24 v81, 6554, v80
  v_lshrrev_b32 v81, 16, v81
  v_mul_u32_u24 v178, 10, v81
  v_sub_u32 v178, v80, v178
  v_mul_u32_u24 v81, 2560, v81
  v_lshl_add_u32 v81, v178, 4, v81
  v_lshlrev_b32 v80, 4, v80
  v_add_u32 v80, s52, v80
  v_add_u32 v82, 192, v1
  v_mul_u32_u24 v83, 6554, v82
  v_lshrrev_b32 v83, 16, v83
  v_mul_u32_u24 v178, 10, v83
  v_sub_u32 v178, v82, v178
  v_mul_u32_u24 v83, 2560, v83
  v_lshl_add_u32 v83, v178, 4, v83
  v_lshlrev_b32 v82, 4, v82
  v_add_u32 v82, s52, v82
  v_add_u32 v84, 256, v1
  v_mul_u32_u24 v85, 6554, v84
  v_lshrrev_b32 v85, 16, v85
  v_mul_u32_u24 v178, 10, v85
  v_sub_u32 v178, v84, v178
  v_mul_u32_u24 v85, 2560, v85
  v_lshl_add_u32 v85, v178, 4, v85
  v_lshlrev_b32 v84, 4, v84
  v_add_u32 v84, s52, v84
  s_waitcnt lgkmcnt(0)
  ds_read_b128 v[96:99], v76
  ds_read_b128 v[100:103], v78
  ds_read_b128 v[104:107], v80
  ds_read_b128 v[108:111], v82
  ds_read_b128 v[112:115], v84
  s_waitcnt lgkmcnt(4)
  buffer_store_dwordx4 v[96:99], v77, s[16:19], s53 offen
  s_waitcnt lgkmcnt(3)
  buffer_store_dwordx4 v[100:103], v79, s[16:19], s53 offen
  s_waitcnt lgkmcnt(2)
  buffer_store_dwordx4 v[104:107], v81, s[16:19], s53 offen
  s_waitcnt lgkmcnt(1)
  buffer_store_dwordx4 v[108:111], v83, s[16:19], s53 offen
  s_waitcnt lgkmcnt(0)
  buffer_store_dwordx4 v[112:115], v85, s[16:19], s53 offen
  s_endpgm
concat_heads__grouped_kv_mqa__linear_kernel_hedgehog__prompt_kernel_ra:
  s_lshr_b32 s52, s3, 1
  s_and_b32 s53, s3, 1
  s_lshl_b32 s54, s41, 2
  s_lshl_b32 s55, s52, 1
  s_add_u32 s54, s54, s55
  s_lshl_b32 s54, s54, 5
  s_lshl_b32 s55, s42, 3
  s_add_u32 s54, s54, s55
  s_lshl_b32 s55, s53, 2
  s_add_u32 s54, s54, s55
  s_mul_i32 s54, s54, 1536
  s_add_u32 s54, s54, 0
  v_lshrrev_b32 v175, 4, v1
  v_mul_u32_u24 v175, 1536, v175
  v_and_b32 v176, 15, v1
  v_lshl_add_u32 v177, v176, 4, v175
  s_mov_b32 s56, 0x3ea52b5c
  s_mov_b32 s57, s56
  v_pk_mul_f32 v[16:17], v[16:17], s[56:57]
  v_pk_mul_f32 v[18:19], v[18:19], s[56:57]
  v_pk_mul_f32 v[32:33], v[32:33], s[56:57]
  v_pk_mul_f32 v[34:35], v[34:35], s[56:57]
  v_pk_mul_f32 v[48:49], v[48:49], s[56:57]
  v_pk_mul_f32 v[50:51], v[50:51], s[56:57]
  v_pk_mul_f32 v[64:65], v[64:65], s[56:57]
  v_pk_mul_f32 v[66:67], v[66:67], s[56:57]
  v_pk_mul_f32 v[80:81], v[80:81], s[56:57]
  v_pk_mul_f32 v[82:83], v[82:83], s[56:57]
  v_cvt_pk_bf16_f32 v160, v16, v17
  v_cvt_pk_bf16_f32 v161, v18, v19
  v_cvt_pk_bf16_f32 v162, v32, v33
  v_cvt_pk_bf16_f32 v163, v34, v35
  v_cvt_pk_bf16_f32 v164, v48, v49
  v_cvt_pk_bf16_f32 v165, v50, v51
  v_cvt_pk_bf16_f32 v166, v64, v65
  v_cvt_pk_bf16_f32 v167, v66, v67
  v_cvt_pk_bf16_f32 v168, v80, v81
  v_cvt_pk_bf16_f32 v169, v82, v83
  v_mov_b32 v170, 0
  v_dot2c_f32_bf16 v170, v160, v160
  v_dot2c_f32_bf16 v170, v161, v161
  v_dot2c_f32_bf16 v170, v162, v162
  v_dot2c_f32_bf16 v170, v163, v163
  v_dot2c_f32_bf16 v170, v164, v164
  v_dot2c_f32_bf16 v170, v165, v165
  v_dot2c_f32_bf16 v170, v166, v166
  v_dot2c_f32_bf16 v170, v167, v167
  v_dot2c_f32_bf16 v170, v168, v168
  v_dot2c_f32_bf16 v170, v169, v169
  v_mov_b32 v171, 0
  buffer_store_dwordx4 v[160:163], v177, s[16:19], s54 offen offset:0 sc0 sc1
  s_nop 0
  v_sqrt_f32 v170, v170
  buffer_store_dwordx4 v[164:167], v177, s[16:19], s54 offen offset:512 sc0 sc1
  buffer_store_dwordx4 v[168:171], v177, s[16:19], s54 offen offset:1024 sc0 sc1
  v_pk_mul_f32 v[20:21], v[20:21], s[56:57]
  v_pk_mul_f32 v[22:23], v[22:23], s[56:57]
  v_pk_mul_f32 v[36:37], v[36:37], s[56:57]
  v_pk_mul_f32 v[38:39], v[38:39], s[56:57]
  v_pk_mul_f32 v[52:53], v[52:53], s[56:57]
  v_pk_mul_f32 v[54:55], v[54:55], s[56:57]
  v_pk_mul_f32 v[68:69], v[68:69], s[56:57]
  v_pk_mul_f32 v[70:71], v[70:71], s[56:57]
  v_pk_mul_f32 v[84:85], v[84:85], s[56:57]
  v_pk_mul_f32 v[86:87], v[86:87], s[56:57]
  v_cvt_pk_bf16_f32 v184, v20, v21
  v_cvt_pk_bf16_f32 v185, v22, v23
  v_cvt_pk_bf16_f32 v186, v36, v37
  v_cvt_pk_bf16_f32 v187, v38, v39
  v_cvt_pk_bf16_f32 v188, v52, v53
  v_cvt_pk_bf16_f32 v189, v54, v55
  v_cvt_pk_bf16_f32 v190, v68, v69
  v_cvt_pk_bf16_f32 v191, v70, v71
  v_cvt_pk_bf16_f32 v192, v84, v85
  v_cvt_pk_bf16_f32 v193, v86, v87
  v_mov_b32 v194, 0
  v_dot2c_f32_bf16 v194, v184, v184
  v_dot2c_f32_bf16 v194, v185, v185
  v_dot2c_f32_bf16 v194, v186, v186
  v_dot2c_f32_bf16 v194, v187, v187
  v_dot2c_f32_bf16 v194, v188, v188
  v_dot2c_f32_bf16 v194, v189, v189
  v_dot2c_f32_bf16 v194, v190, v190
  v_dot2c_f32_bf16 v194, v191, v191
  v_dot2c_f32_bf16 v194, v192, v192
  v_dot2c_f32_bf16 v194, v193, v193
  v_mov_b32 v195, 0
  buffer_store_dwordx4 v[184:187], v177, s[16:19], s54 offen offset:256 sc0 sc1
  s_nop 0
  v_sqrt_f32 v194, v194
  buffer_store_dwordx4 v[188:191], v177, s[16:19], s54 offen offset:768 sc0 sc1
  buffer_store_dwordx4 v[192:195], v177, s[16:19], s54 offen offset:1280 sc0 sc1
  s_add_u32 s54, s54, 49152
  s_barrier
  v_pk_mul_f32 v[24:25], v[24:25], s[56:57]
  v_pk_mul_f32 v[26:27], v[26:27], s[56:57]
  v_pk_mul_f32 v[40:41], v[40:41], s[56:57]
  v_pk_mul_f32 v[42:43], v[42:43], s[56:57]
  v_pk_mul_f32 v[56:57], v[56:57], s[56:57]
  v_pk_mul_f32 v[58:59], v[58:59], s[56:57]
  v_pk_mul_f32 v[72:73], v[72:73], s[56:57]
  v_pk_mul_f32 v[74:75], v[74:75], s[56:57]
  v_pk_mul_f32 v[88:89], v[88:89], s[56:57]
  v_pk_mul_f32 v[90:91], v[90:91], s[56:57]
  v_cvt_pk_bf16_f32 v160, v24, v25
  v_cvt_pk_bf16_f32 v161, v26, v27
  v_cvt_pk_bf16_f32 v162, v40, v41
  v_cvt_pk_bf16_f32 v163, v42, v43
  v_cvt_pk_bf16_f32 v164, v56, v57
  v_cvt_pk_bf16_f32 v165, v58, v59
  v_cvt_pk_bf16_f32 v166, v72, v73
  v_cvt_pk_bf16_f32 v167, v74, v75
  v_cvt_pk_bf16_f32 v168, v88, v89
  v_cvt_pk_bf16_f32 v169, v90, v91
  v_mov_b32 v170, 0
  v_dot2c_f32_bf16 v170, v160, v160
  v_dot2c_f32_bf16 v170, v161, v161
  v_dot2c_f32_bf16 v170, v162, v162
  v_dot2c_f32_bf16 v170, v163, v163
  v_dot2c_f32_bf16 v170, v164, v164
  v_dot2c_f32_bf16 v170, v165, v165
  v_dot2c_f32_bf16 v170, v166, v166
  v_dot2c_f32_bf16 v170, v167, v167
  v_dot2c_f32_bf16 v170, v168, v168
  v_dot2c_f32_bf16 v170, v169, v169
  v_mov_b32 v171, 0
  buffer_store_dwordx4 v[160:163], v177, s[16:19], s54 offen offset:0 sc0 sc1
  s_nop 0
  v_sqrt_f32 v170, v170
  buffer_store_dwordx4 v[164:167], v177, s[16:19], s54 offen offset:512 sc0 sc1
  buffer_store_dwordx4 v[168:171], v177, s[16:19], s54 offen offset:1024 sc0 sc1
  v_pk_mul_f32 v[28:29], v[28:29], s[56:57]
  v_pk_mul_f32 v[30:31], v[30:31], s[56:57]
  v_pk_mul_f32 v[44:45], v[44:45], s[56:57]
  v_pk_mul_f32 v[46:47], v[46:47], s[56:57]
  v_pk_mul_f32 v[60:61], v[60:61], s[56:57]
  v_pk_mul_f32 v[62:63], v[62:63], s[56:57]
  v_pk_mul_f32 v[76:77], v[76:77], s[56:57]
  v_pk_mul_f32 v[78:79], v[78:79], s[56:57]
  v_pk_mul_f32 v[92:93], v[92:93], s[56:57]
  v_pk_mul_f32 v[94:95], v[94:95], s[56:57]
  v_cvt_pk_bf16_f32 v184, v28, v29
  v_cvt_pk_bf16_f32 v185, v30, v31
  v_cvt_pk_bf16_f32 v186, v44, v45
  v_cvt_pk_bf16_f32 v187, v46, v47
  v_cvt_pk_bf16_f32 v188, v60, v61
  v_cvt_pk_bf16_f32 v189, v62, v63
  v_cvt_pk_bf16_f32 v190, v76, v77
  v_cvt_pk_bf16_f32 v191, v78, v79
  v_cvt_pk_bf16_f32 v192, v92, v93
  v_cvt_pk_bf16_f32 v193, v94, v95
  v_mov_b32 v194, 0
  v_dot2c_f32_bf16 v194, v184, v184
  v_dot2c_f32_bf16 v194, v185, v185
  v_dot2c_f32_bf16 v194, v186, v186
  v_dot2c_f32_bf16 v194, v187, v187
  v_dot2c_f32_bf16 v194, v188, v188
  v_dot2c_f32_bf16 v194, v189, v189
  v_dot2c_f32_bf16 v194, v190, v190
  v_dot2c_f32_bf16 v194, v191, v191
  v_dot2c_f32_bf16 v194, v192, v192
  v_dot2c_f32_bf16 v194, v193, v193
  v_mov_b32 v195, 0
  buffer_store_dwordx4 v[184:187], v177, s[16:19], s54 offen offset:256 sc0 sc1
  s_nop 0
  v_sqrt_f32 v194, v194
  buffer_store_dwordx4 v[188:191], v177, s[16:19], s54 offen offset:768 sc0 sc1
  buffer_store_dwordx4 v[192:195], v177, s[16:19], s54 offen offset:1280 sc0 sc1
  s_barrier
  s_barrier
  s_waitcnt vmcnt(0)
  s_branch concat_heads__grouped_kv_mqa__linear_kernel_hedgehog__prompt_kernel_fin
concat_heads__grouped_kv_mqa__linear_kernel_hedgehog__prompt_kernel_rbq:
  s_and_b32 s53, s3, 1
  v_cvt_pk_bf16_f32 v96, v16, v17
  v_cvt_pk_bf16_f32 v97, v18, v19
  v_cvt_pk_bf16_f32 v98, v32, v33
  v_cvt_pk_bf16_f32 v99, v34, v35
  v_cvt_pk_bf16_f32 v100, v48, v49
  v_cvt_pk_bf16_f32 v101, v50, v51
  v_cvt_pk_bf16_f32 v102, v64, v65
  v_cvt_pk_bf16_f32 v103, v66, v67
  v_cvt_pk_bf16_f32 v104, v80, v81
  v_cvt_pk_bf16_f32 v105, v82, v83
  v_mov_b32 v106, 0
  v_mov_b32 v107, 0
  v_cvt_pk_bf16_f32 v108, v20, v21
  v_cvt_pk_bf16_f32 v109, v22, v23
  v_cvt_pk_bf16_f32 v110, v36, v37
  v_cvt_pk_bf16_f32 v111, v38, v39
  v_cvt_pk_bf16_f32 v112, v52, v53
  v_cvt_pk_bf16_f32 v113, v54, v55
  v_cvt_pk_bf16_f32 v114, v68, v69
  v_cvt_pk_bf16_f32 v115, v70, v71
  v_cvt_pk_bf16_f32 v116, v84, v85
  v_cvt_pk_bf16_f32 v117, v86, v87
  v_mov_b32 v118, 0
  v_mov_b32 v119, 0
  v_cvt_pk_bf16_f32 v120, v24, v25
  v_cvt_pk_bf16_f32 v121, v26, v27
  v_cvt_pk_bf16_f32 v122, v40, v41
  v_cvt_pk_bf16_f32 v123, v42, v43
  v_cvt_pk_bf16_f32 v124, v56, v57
  v_cvt_pk_bf16_f32 v125, v58, v59
  v_cvt_pk_bf16_f32 v126, v72, v73
  v_cvt_pk_bf16_f32 v127, v74, v75
  v_cvt_pk_bf16_f32 v128, v88, v89
  v_cvt_pk_bf16_f32 v129, v90, v91
  v_mov_b32 v130, 0
  v_mov_b32 v131, 0
  v_cvt_pk_bf16_f32 v132, v28, v29
  v_cvt_pk_bf16_f32 v133, v30, v31
  v_cvt_pk_bf16_f32 v134, v44, v45
  v_cvt_pk_bf16_f32 v135, v46, v47
  v_cvt_pk_bf16_f32 v136, v60, v61
  v_cvt_pk_bf16_f32 v137, v62, v63
  v_cvt_pk_bf16_f32 v138, v76, v77
  v_cvt_pk_bf16_f32 v139, v78, v79
  v_cvt_pk_bf16_f32 v140, v92, v93
  v_cvt_pk_bf16_f32 v141, v94, v95
  v_mov_b32 v142, 0
  v_mov_b32 v143, 0
  s_lshr_b32 s52, s3, 1
  s_lshl_b32 s54, s41, 3
  s_lshl_b32 s55, s52, 2
  s_add_u32 s54, s54, s55
  s_lshl_b32 s54, s54, 3
  s_lshl_b32 s55, s42, 1
  s_add_u32 s54, s54, s55
  s_add_u32 s54, s54, s53
  s_mul_i32 s54, s54, 2560
  s_add_u32 s54, s54, 10485760
  v_lshlrev_b32 v176, 4, v1
  v_lshlrev_b32 v177, 3, v1
  v_mfma_f32_16x16x32_bf16 v[56:59], v[196:199], v[96:99], 0
  v_mfma_f32_16x16x32_bf16 v[60:63], v[208:211], v[96:99], 0
  v_mfma_f32_16x16x32_bf16 v[64:67], v[220:223], v[96:99], 0
  v_mfma_f32_16x16x32_bf16 v[68:71], v[232:235], v[96:99], 0
  v_mfma_f32_16x16x32_bf16 v[72:75], v[244:247], v[96:99], 0
  v_mfma_f32_16x16x32_bf16 v[56:59], v[200:203], v[100:103], v[56:59]
  v_mfma_f32_16x16x32_bf16 v[60:63], v[212:215], v[100:103], v[60:63]
  v_mfma_f32_16x16x32_bf16 v[64:67], v[224:227], v[100:103], v[64:67]
  v_mfma_f32_16x16x32_bf16 v[68:71], v[236:239], v[100:103], v[68:71]
  v_mfma_f32_16x16x32_bf16 v[72:75], v[248:251], v[100:103], v[72:75]
  v_mfma_f32_16x16x32_bf16 v[56:59], v[204:207], v[104:107], v[56:59]
  v_mfma_f32_16x16x32_bf16 v[60:63], v[216:219], v[104:107], v[60:63]
  v_mfma_f32_16x16x32_bf16 v[64:67], v[228:231], v[104:107], v[64:67]
  v_mfma_f32_16x16x32_bf16 v[68:71], v[240:243], v[104:107], v[68:71]
  v_mfma_f32_16x16x32_bf16 v[72:75], v[252:255], v[104:107], v[72:75]
  v_mfma_f32_16x16x32_bf16 v[76:79], v[196:199], v[108:111], 0
  v_mfma_f32_16x16x32_bf16 v[80:83], v[208:211], v[108:111], 0
  v_mfma_f32_16x16x32_bf16 v[84:87], v[220:223], v[108:111], 0
  v_mfma_f32_16x16x32_bf16 v[88:91], v[232:235], v[108:111], 0
  v_mfma_f32_16x16x32_bf16 v[92:95], v[244:247], v[108:111], 0
  v_mfma_f32_16x16x32_bf16 v[76:79], v[200:203], v[112:115], v[76:79]
  v_mfma_f32_16x16x32_bf16 v[80:83], v[212:215], v[112:115], v[80:83]
  v_mfma_f32_16x16x32_bf16 v[84:87], v[224:227], v[112:115], v[84:87]
  v_mfma_f32_16x16x32_bf16 v[88:91], v[236:239], v[112:115], v[88:91]
  v_mfma_f32_16x16x32_bf16 v[92:95], v[248:251], v[112:115], v[92:95]
  v_mfma_f32_16x16x32_bf16 v[76:79], v[204:207], v[116:119], v[76:79]
  v_mfma_f32_16x16x32_bf16 v[80:83], v[216:219], v[116:119], v[80:83]
  v_mfma_f32_16x16x32_bf16 v[84:87], v[228:231], v[116:119], v[84:87]
  v_mfma_f32_16x16x32_bf16 v[88:91], v[240:243], v[116:119], v[88:91]
  v_mfma_f32_16x16x32_bf16 v[92:95], v[252:255], v[116:119], v[92:95]
  s_nop 1
  v_cvt_pk_bf16_f32 v96, v56, v57
  v_cvt_pk_bf16_f32 v97, v58, v59
  v_cvt_pk_bf16_f32 v98, v60, v61
  v_cvt_pk_bf16_f32 v99, v62, v63
  v_cvt_pk_bf16_f32 v100, v64, v65
  v_cvt_pk_bf16_f32 v101, v66, v67
  v_cvt_pk_bf16_f32 v102, v68, v69
  v_cvt_pk_bf16_f32 v103, v70, v71
  v_cvt_pk_bf16_f32 v104, v72, v73
  v_cvt_pk_bf16_f32 v105, v74, v75
  buffer_store_dwordx4 v[96:99], v176, s[16:19], s54 offen sc0 sc1
  buffer_store_dwordx4 v[100:103], v176, s[16:19], s54 offen offset:1024 sc0 sc1
  buffer_store_dwordx2 v[104:105], v177, s[16:19], s54 offen offset:2048 sc0 sc1
  s_add_u32 s54, s54, 20480
  v_mfma_f32_16x16x32_bf16 v[56:59], v[196:199], v[120:123], 0
  v_mfma_f32_16x16x32_bf16 v[60:63], v[208:211], v[120:123], 0
  v_mfma_f32_16x16x32_bf16 v[64:67], v[220:223], v[120:123], 0
  v_mfma_f32_16x16x32_bf16 v[68:71], v[232:235], v[120:123], 0
  v_mfma_f32_16x16x32_bf16 v[72:75], v[244:247], v[120:123], 0
  v_mfma_f32_16x16x32_bf16 v[56:59], v[200:203], v[124:127], v[56:59]
  v_mfma_f32_16x16x32_bf16 v[60:63], v[212:215], v[124:127], v[60:63]
  v_mfma_f32_16x16x32_bf16 v[64:67], v[224:227], v[124:127], v[64:67]
  v_mfma_f32_16x16x32_bf16 v[68:71], v[236:239], v[124:127], v[68:71]
  v_mfma_f32_16x16x32_bf16 v[72:75], v[248:251], v[124:127], v[72:75]
  v_mfma_f32_16x16x32_bf16 v[56:59], v[204:207], v[128:131], v[56:59]
  v_mfma_f32_16x16x32_bf16 v[60:63], v[216:219], v[128:131], v[60:63]
  v_mfma_f32_16x16x32_bf16 v[64:67], v[228:231], v[128:131], v[64:67]
  v_mfma_f32_16x16x32_bf16 v[68:71], v[240:243], v[128:131], v[68:71]
  v_mfma_f32_16x16x32_bf16 v[72:75], v[252:255], v[128:131], v[72:75]
  s_nop 1
  v_cvt_pk_bf16_f32 v108, v76, v77
  v_cvt_pk_bf16_f32 v109, v78, v79
  v_cvt_pk_bf16_f32 v110, v80, v81
  v_cvt_pk_bf16_f32 v111, v82, v83
  v_cvt_pk_bf16_f32 v112, v84, v85
  v_cvt_pk_bf16_f32 v113, v86, v87
  v_cvt_pk_bf16_f32 v114, v88, v89
  v_cvt_pk_bf16_f32 v115, v90, v91
  v_cvt_pk_bf16_f32 v116, v92, v93
  v_cvt_pk_bf16_f32 v117, v94, v95
  buffer_store_dwordx4 v[108:111], v176, s[16:19], s54 offen sc0 sc1
  buffer_store_dwordx4 v[112:115], v176, s[16:19], s54 offen offset:1024 sc0 sc1
  buffer_store_dwordx2 v[116:117], v177, s[16:19], s54 offen offset:2048 sc0 sc1
  s_add_u32 s54, s54, 20480
  v_mfma_f32_16x16x32_bf16 v[76:79], v[196:199], v[132:135], 0
  v_mfma_f32_16x16x32_bf16 v[80:83], v[208:211], v[132:135], 0
  v_mfma_f32_16x16x32_bf16 v[84:87], v[220:223], v[132:135], 0
  v_mfma_f32_16x16x32_bf16 v[88:91], v[232:235], v[132:135], 0
  v_mfma_f32_16x16x32_bf16 v[92:95], v[244:247], v[132:135], 0
  v_mfma_f32_16x16x32_bf16 v[76:79], v[200:203], v[136:139], v[76:79]
  v_mfma_f32_16x16x32_bf16 v[80:83], v[212:215], v[136:139], v[80:83]
  v_mfma_f32_16x16x32_bf16 v[84:87], v[224:227], v[136:139], v[84:87]
  v_mfma_f32_16x16x32_bf16 v[88:91], v[236:239], v[136:139], v[88:91]
  v_mfma_f32_16x16x32_bf16 v[92:95], v[248:251], v[136:139], v[92:95]
  v_mfma_f32_16x16x32_bf16 v[76:79], v[204:207], v[140:143], v[76:79]
  v_mfma_f32_16x16x32_bf16 v[80:83], v[216:219], v[140:143], v[80:83]
  v_mfma_f32_16x16x32_bf16 v[84:87], v[228:231], v[140:143], v[84:87]
  v_mfma_f32_16x16x32_bf16 v[88:91], v[240:243], v[140:143], v[88:91]
  v_mfma_f32_16x16x32_bf16 v[92:95], v[252:255], v[140:143], v[92:95]
  s_nop 1
  v_cvt_pk_bf16_f32 v120, v56, v57
  v_cvt_pk_bf16_f32 v121, v58, v59
  v_cvt_pk_bf16_f32 v122, v60, v61
  v_cvt_pk_bf16_f32 v123, v62, v63
  v_cvt_pk_bf16_f32 v124, v64, v65
  v_cvt_pk_bf16_f32 v125, v66, v67
  v_cvt_pk_bf16_f32 v126, v68, v69
  v_cvt_pk_bf16_f32 v127, v70, v71
  v_cvt_pk_bf16_f32 v128, v72, v73
  v_cvt_pk_bf16_f32 v129, v74, v75
  buffer_store_dwordx4 v[120:123], v176, s[16:19], s54 offen sc0 sc1
  buffer_store_dwordx4 v[124:127], v176, s[16:19], s54 offen offset:1024 sc0 sc1
  buffer_store_dwordx2 v[128:129], v177, s[16:19], s54 offen offset:2048 sc0 sc1
  s_add_u32 s54, s54, 20480
  s_nop 7
  s_nop 1
  v_cvt_pk_bf16_f32 v132, v76, v77
  v_cvt_pk_bf16_f32 v133, v78, v79
  v_cvt_pk_bf16_f32 v134, v80, v81
  v_cvt_pk_bf16_f32 v135, v82, v83
  v_cvt_pk_bf16_f32 v136, v84, v85
  v_cvt_pk_bf16_f32 v137, v86, v87
  v_cvt_pk_bf16_f32 v138, v88, v89
  v_cvt_pk_bf16_f32 v139, v90, v91
  v_cvt_pk_bf16_f32 v140, v92, v93
  v_cvt_pk_bf16_f32 v141, v94, v95
  buffer_store_dwordx4 v[132:135], v176, s[16:19], s54 offen sc0 sc1
  buffer_store_dwordx4 v[136:139], v176, s[16:19], s54 offen offset:1024 sc0 sc1
  buffer_store_dwordx2 v[140:141], v177, s[16:19], s54 offen offset:2048 sc0 sc1
  s_barrier
  s_barrier
  s_branch concat_heads__grouped_kv_mqa__linear_kernel_hedgehog__prompt_kernel_fin
concat_heads__grouped_kv_mqa__linear_kernel_hedgehog__prompt_kernel_fb:
  s_mov_b32 s101, 1
  s_waitcnt lgkmcnt(0)
  s_lshr_b32 s12, s2, 2
  s_lshl_b32 s12, s12, 5
  s_and_b32 s13, s2, 3
  s_lshl_b32 s13, s13, 3
  s_add_u32 s12, s12, s13
  s_mul_i32 s12, s12, 1536
  s_add_u32 s12, s12, 0
  v_and_b32 v3, 31, v2
  v_lshlrev_b32 v3, 4, v3
  v_add_u32 v3, 1024, v3
  buffer_load_dwordx4 v[4:7], v120, s[8:11], s12 offen
  buffer_load_dwordx2 v[36:37], v3, s[8:11], s12 offen
  s_add_u32 s12, s12, 1536
  buffer_load_dwordx4 v[8:11], v120, s[8:11], s12 offen
  buffer_load_dwordx2 v[38:39], v3, s[8:11], s12 offen
  s_add_u32 s12, s12, 1536
  buffer_load_dwordx4 v[12:15], v120, s[8:11], s12 offen
  buffer_load_dwordx2 v[40:41], v3, s[8:11], s12 offen
  s_add_u32 s12, s12, 1536
  buffer_load_dwordx4 v[16:19], v120, s[8:11], s12 offen
  buffer_load_dwordx2 v[42:43], v3, s[8:11], s12 offen
  s_add_u32 s12, s12, 1536
  buffer_load_dwordx4 v[20:23], v120, s[8:11], s12 offen
  buffer_load_dwordx2 v[44:45], v3, s[8:11], s12 offen
  s_add_u32 s12, s12, 1536
  buffer_load_dwordx4 v[24:27], v120, s[8:11], s12 offen
  buffer_load_dwordx2 v[46:47], v3, s[8:11], s12 offen
  s_add_u32 s12, s12, 1536
  buffer_load_dwordx4 v[28:31], v120, s[8:11], s12 offen
  buffer_load_dwordx2 v[48:49], v3, s[8:11], s12 offen
  s_add_u32 s12, s12, 1536
  buffer_load_dwordx4 v[32:35], v120, s[8:11], s12 offen
  buffer_load_dwordx2 v[50:51], v3, s[8:11], s12 offen
  s_add_u32 s12, s12, 1536
  s_waitcnt vmcnt(0)
  v_cmp_gt_u32 vcc, 32, v2
  s_nop 1
  v_cndmask_b32 v36, 0, v36, vcc
  v_cndmask_b32 v37, 0, v37, vcc
  v_cndmask_b32 v38, 0, v38, vcc
  v_cndmask_b32 v39, 0, v39, vcc
  v_cndmask_b32 v40, 0, v40, vcc
  v_cndmask_b32 v41, 0, v41, vcc
  v_cndmask_b32 v42, 0, v42, vcc
  v_cndmask_b32 v43, 0, v43, vcc
  v_cndmask_b32 v44, 0, v44, vcc
  v_cndmask_b32 v45, 0, v45, vcc
  v_cndmask_b32 v46, 0, v46, vcc
  v_cndmask_b32 v47, 0, v47, vcc
  v_cndmask_b32 v48, 0, v48, vcc
  v_cndmask_b32 v49, 0, v49, vcc
  v_cndmask_b32 v50, 0, v50, vcc
  v_cndmask_b32 v51, 0, v51, vcc
  v_mov_b32 v110, 0xff800000
  v_mov_b32 v111, 0xff800000
  v_mov_b32 v112, 0xff800000
  v_mov_b32 v113, 0xff800000
  v_mov_b32 v114, 0xff800000
  v_mov_b32 v115, 0xff800000
  v_mov_b32 v116, 0xff800000
  v_mov_b32 v117, 0xff800000
  s_mul_i32 s20, s3, 57344
  s_add_u32 s20, s20, 3145728
  s_mov_b32 s25, 16
concat_heads__grouped_kv_mqa__linear_kernel_hedgehog__prompt_kernel_fb1:
  buffer_load_dwordx4 v[92:95], v120, s[8:11], s20 offen
  buffer_load_dwordx2 v[104:105], v121, s[8:11], s20 offen offset:3072
  s_waitcnt vmcnt(0)
  v_mfma_f32_32x32x16_bf16 v[52:67], v[92:95], v[4:7], 0
  v_mfma_f32_32x32x8_bf16 v[52:67], v[104:105], v[36:37], v[52:67]
  s_nop 15
  s_nop 7
  v_max3_f32 v110, v110, v52, v53
  v_max3_f32 v110, v110, v54, v55
  v_max3_f32 v110, v110, v56, v57
  v_max3_f32 v110, v110, v58, v59
  v_max3_f32 v110, v110, v60, v61
  v_max3_f32 v110, v110, v62, v63
  v_max3_f32 v110, v110, v64, v65
  v_max3_f32 v110, v110, v66, v67
  s_nop 7
  v_mfma_f32_32x32x16_bf16 v[52:67], v[92:95], v[8:11], 0
  v_mfma_f32_32x32x8_bf16 v[52:67], v[104:105], v[38:39], v[52:67]
  s_nop 15
  s_nop 7
  v_max3_f32 v111, v111, v52, v53
  v_max3_f32 v111, v111, v54, v55
  v_max3_f32 v111, v111, v56, v57
  v_max3_f32 v111, v111, v58, v59
  v_max3_f32 v111, v111, v60, v61
  v_max3_f32 v111, v111, v62, v63
  v_max3_f32 v111, v111, v64, v65
  v_max3_f32 v111, v111, v66, v67
  s_nop 7
  v_mfma_f32_32x32x16_bf16 v[52:67], v[92:95], v[12:15], 0
  v_mfma_f32_32x32x8_bf16 v[52:67], v[104:105], v[40:41], v[52:67]
  s_nop 15
  s_nop 7
  v_max3_f32 v112, v112, v52, v53
  v_max3_f32 v112, v112, v54, v55
  v_max3_f32 v112, v112, v56, v57
  v_max3_f32 v112, v112, v58, v59
  v_max3_f32 v112, v112, v60, v61
  v_max3_f32 v112, v112, v62, v63
  v_max3_f32 v112, v112, v64, v65
  v_max3_f32 v112, v112, v66, v67
  s_nop 7
  v_mfma_f32_32x32x16_bf16 v[52:67], v[92:95], v[16:19], 0
  v_mfma_f32_32x32x8_bf16 v[52:67], v[104:105], v[42:43], v[52:67]
  s_nop 15
  s_nop 7
  v_max3_f32 v113, v113, v52, v53
  v_max3_f32 v113, v113, v54, v55
  v_max3_f32 v113, v113, v56, v57
  v_max3_f32 v113, v113, v58, v59
  v_max3_f32 v113, v113, v60, v61
  v_max3_f32 v113, v113, v62, v63
  v_max3_f32 v113, v113, v64, v65
  v_max3_f32 v113, v113, v66, v67
  s_nop 7
  v_mfma_f32_32x32x16_bf16 v[52:67], v[92:95], v[20:23], 0
  v_mfma_f32_32x32x8_bf16 v[52:67], v[104:105], v[44:45], v[52:67]
  s_nop 15
  s_nop 7
  v_max3_f32 v114, v114, v52, v53
  v_max3_f32 v114, v114, v54, v55
  v_max3_f32 v114, v114, v56, v57
  v_max3_f32 v114, v114, v58, v59
  v_max3_f32 v114, v114, v60, v61
  v_max3_f32 v114, v114, v62, v63
  v_max3_f32 v114, v114, v64, v65
  v_max3_f32 v114, v114, v66, v67
  s_nop 7
  v_mfma_f32_32x32x16_bf16 v[52:67], v[92:95], v[24:27], 0
  v_mfma_f32_32x32x8_bf16 v[52:67], v[104:105], v[46:47], v[52:67]
  s_nop 15
  s_nop 7
  v_max3_f32 v115, v115, v52, v53
  v_max3_f32 v115, v115, v54, v55
  v_max3_f32 v115, v115, v56, v57
  v_max3_f32 v115, v115, v58, v59
  v_max3_f32 v115, v115, v60, v61
  v_max3_f32 v115, v115, v62, v63
  v_max3_f32 v115, v115, v64, v65
  v_max3_f32 v115, v115, v66, v67
  s_nop 7
  v_mfma_f32_32x32x16_bf16 v[52:67], v[92:95], v[28:31], 0
  v_mfma_f32_32x32x8_bf16 v[52:67], v[104:105], v[48:49], v[52:67]
  s_nop 15
  s_nop 7
  v_max3_f32 v116, v116, v52, v53
  v_max3_f32 v116, v116, v54, v55
  v_max3_f32 v116, v116, v56, v57
  v_max3_f32 v116, v116, v58, v59
  v_max3_f32 v116, v116, v60, v61
  v_max3_f32 v116, v116, v62, v63
  v_max3_f32 v116, v116, v64, v65
  v_max3_f32 v116, v116, v66, v67
  s_nop 7
  v_mfma_f32_32x32x16_bf16 v[52:67], v[92:95], v[32:35], 0
  v_mfma_f32_32x32x8_bf16 v[52:67], v[104:105], v[50:51], v[52:67]
  s_nop 15
  s_nop 7
  v_max3_f32 v117, v117, v52, v53
  v_max3_f32 v117, v117, v54, v55
  v_max3_f32 v117, v117, v56, v57
  v_max3_f32 v117, v117, v58, v59
  v_max3_f32 v117, v117, v60, v61
  v_max3_f32 v117, v117, v62, v63
  v_max3_f32 v117, v117, v64, v65
  v_max3_f32 v117, v117, v66, v67
  s_nop 7
  s_add_u32 s20, s20, 3584
  s_sub_u32 s25, s25, 1
  s_cmp_lg_u32 s25, 0
  s_cbranch_scc1 concat_heads__grouped_kv_mqa__linear_kernel_hedgehog__prompt_kernel_fb1
  v_mov_b32 v3, v110
  s_nop 1
  v_permlane32_swap_b32 v110, v3
  s_nop 1
  v_max_f32 v110, v110, v3
  v_mov_b32 v3, v111
  s_nop 1
  v_permlane32_swap_b32 v111, v3
  s_nop 1
  v_max_f32 v111, v111, v3
  v_mov_b32 v3, v112
  s_nop 1
  v_permlane32_swap_b32 v112, v3
  s_nop 1
  v_max_f32 v112, v112, v3
  v_mov_b32 v3, v113
  s_nop 1
  v_permlane32_swap_b32 v113, v3
  s_nop 1
  v_max_f32 v113, v113, v3
  v_mov_b32 v3, v114
  s_nop 1
  v_permlane32_swap_b32 v114, v3
  s_nop 1
  v_max_f32 v114, v114, v3
  v_mov_b32 v3, v115
  s_nop 1
  v_permlane32_swap_b32 v115, v3
  s_nop 1
  v_max_f32 v115, v115, v3
  v_mov_b32 v3, v116
  s_nop 1
  v_permlane32_swap_b32 v116, v3
  s_nop 1
  v_max_f32 v116, v116, v3
  v_mov_b32 v3, v117
  s_nop 1
  v_permlane32_swap_b32 v117, v3
  s_nop 1
  v_max_f32 v117, v117, v3
  s_mul_i32 s26, s3, 28672
  v_lshlrev_b32 v3, 2, v2
  v_add_u32 v108, s26, v3
  ds_write_b32 v108, v110 offset:0
  ds_write_b32 v108, v111 offset:256
  ds_write_b32 v108, v112 offset:512
  ds_write_b32 v108, v113 offset:768
  ds_write_b32 v108, v114 offset:1024
  ds_write_b32 v108, v115 offset:1280
  ds_write_b32 v108, v116 offset:1536
  ds_write_b32 v108, v117 offset:1792
  s_waitcnt lgkmcnt(0)
  s_barrier
  v_add_u32 v109, 0, v3
  ds_read_b32 v52, v109 offset:0
  ds_read_b32 v53, v109 offset:256
  ds_read_b32 v54, v109 offset:512
  ds_read_b32 v55, v109 offset:768
  ds_read_b32 v56, v109 offset:1024
  ds_read_b32 v57, v109 offset:1280
  ds_read_b32 v58, v109 offset:1536
  ds_read_b32 v59, v109 offset:1792
  v_add_u32 v109, 28672, v3
  ds_read_b32 v60, v109 offset:0
  ds_read_b32 v61, v109 offset:256
  ds_read_b32 v62, v109 offset:512
  ds_read_b32 v63, v109 offset:768
  ds_read_b32 v64, v109 offset:1024
  ds_read_b32 v65, v109 offset:1280
  ds_read_b32 v66, v109 offset:1536
  ds_read_b32 v67, v109 offset:1792
  v_add_u32 v109, 57344, v3
  ds_read_b32 v68, v109 offset:0
  ds_read_b32 v69, v109 offset:256
  ds_read_b32 v70, v109 offset:512
  ds_read_b32 v71, v109 offset:768
  ds_read_b32 v72, v109 offset:1024
  ds_read_b32 v73, v109 offset:1280
  ds_read_b32 v74, v109 offset:1536
  ds_read_b32 v75, v109 offset:1792
  v_add_u32 v109, 86016, v3
  ds_read_b32 v76, v109 offset:0
  ds_read_b32 v77, v109 offset:256
  ds_read_b32 v78, v109 offset:512
  ds_read_b32 v79, v109 offset:768
  ds_read_b32 v80, v109 offset:1024
  ds_read_b32 v81, v109 offset:1280
  ds_read_b32 v82, v109 offset:1536
  ds_read_b32 v83, v109 offset:1792
  s_waitcnt lgkmcnt(0)
  v_cmp_gt_u32 vcc, 32, v2
  v_max3_f32 v52, v52, v60, v68
  v_max_f32 v52, v52, v76
  v_and_b32 v3, 0xffff0000, v52
  v_sub_f32 v109, v52, v3
  v_cvt_pk_bf16_f32 v109, v3, v109
  v_xor_b32 v109, 0x80008000, v109
  v_cndmask_b32 v36, v109, v36, vcc
  v_max3_f32 v53, v53, v61, v69
  v_max_f32 v53, v53, v77
  v_and_b32 v3, 0xffff0000, v53
  v_sub_f32 v109, v53, v3
  v_cvt_pk_bf16_f32 v109, v3, v109
  v_xor_b32 v109, 0x80008000, v109
  v_cndmask_b32 v38, v109, v38, vcc
  v_max3_f32 v54, v54, v62, v70
  v_max_f32 v54, v54, v78
  v_and_b32 v3, 0xffff0000, v54
  v_sub_f32 v109, v54, v3
  v_cvt_pk_bf16_f32 v109, v3, v109
  v_xor_b32 v109, 0x80008000, v109
  v_cndmask_b32 v40, v109, v40, vcc
  v_max3_f32 v55, v55, v63, v71
  v_max_f32 v55, v55, v79
  v_and_b32 v3, 0xffff0000, v55
  v_sub_f32 v109, v55, v3
  v_cvt_pk_bf16_f32 v109, v3, v109
  v_xor_b32 v109, 0x80008000, v109
  v_cndmask_b32 v42, v109, v42, vcc
  v_max3_f32 v56, v56, v64, v72
  v_max_f32 v56, v56, v80
  v_and_b32 v3, 0xffff0000, v56
  v_sub_f32 v109, v56, v3
  v_cvt_pk_bf16_f32 v109, v3, v109
  v_xor_b32 v109, 0x80008000, v109
  v_cndmask_b32 v44, v109, v44, vcc
  v_max3_f32 v57, v57, v65, v73
  v_max_f32 v57, v57, v81
  v_and_b32 v3, 0xffff0000, v57
  v_sub_f32 v109, v57, v3
  v_cvt_pk_bf16_f32 v109, v3, v109
  v_xor_b32 v109, 0x80008000, v109
  v_cndmask_b32 v46, v109, v46, vcc
  v_max3_f32 v58, v58, v66, v74
  v_max_f32 v58, v58, v82
  v_and_b32 v3, 0xffff0000, v58
  v_sub_f32 v109, v58, v3
  v_cvt_pk_bf16_f32 v109, v3, v109
  v_xor_b32 v109, 0x80008000, v109
  v_cndmask_b32 v48, v109, v48, vcc
  v_max3_f32 v59, v59, v67, v75
  v_max_f32 v59, v59, v83
  v_and_b32 v3, 0xffff0000, v59
  v_sub_f32 v109, v59, v3
  v_cvt_pk_bf16_f32 v109, v3, v109
  v_xor_b32 v109, 0x80008000, v109
  v_cndmask_b32 v50, v109, v50, vcc
  v_mov_b32 v128, 0
  v_mov_b32 v129, 0
  v_mov_b32 v130, 0
  v_mov_b32 v131, 0
  v_mov_b32 v132, 0
  v_mov_b32 v133, 0
  v_mov_b32 v134, 0
  v_mov_b32 v135, 0
  v_mov_b32 v136, 0
  v_mov_b32 v137, 0
  v_mov_b32 v138, 0
  v_mov_b32 v139, 0
  v_mov_b32 v140, 0
  v_mov_b32 v141, 0
  v_mov_b32 v142, 0
  v_mov_b32 v143, 0
  v_mov_b32 v144, 0
  v_mov_b32 v145, 0
  v_mov_b32 v146, 0
  v_mov_b32 v147, 0
  v_mov_b32 v148, 0
  v_mov_b32 v149, 0
  v_mov_b32 v150, 0
  v_mov_b32 v151, 0
  v_mov_b32 v152, 0
  v_mov_b32 v153, 0
  v_mov_b32 v154, 0
  v_mov_b32 v155, 0
  v_mov_b32 v156, 0
  v_mov_b32 v157, 0
  v_mov_b32 v158, 0
  v_mov_b32 v159, 0
  v_mov_b32 v160, 0
  v_mov_b32 v161, 0
  v_mov_b32 v162, 0
  v_mov_b32 v163, 0
  v_mov_b32 v164, 0
  v_mov_b32 v165, 0
  v_mov_b32 v166, 0
  v_mov_b32 v167, 0
  v_mov_b32 v168, 0
  v_mov_b32 v169, 0
  v_mov_b32 v170, 0
  v_mov_b32 v171, 0
  v_mov_b32 v172, 0
  v_mov_b32 v173, 0
  v_mov_b32 v174, 0
  v_mov_b32 v175, 0
  v_mov_b32 v176, 0
  v_mov_b32 v177, 0
  v_mov_b32 v178, 0
  v_mov_b32 v179, 0
  v_mov_b32 v180, 0
  v_mov_b32 v181, 0
  v_mov_b32 v182, 0
  v_mov_b32 v183, 0
  v_mov_b32 v184, 0
  v_mov_b32 v185, 0
  v_mov_b32 v186, 0
  v_mov_b32 v187, 0
  v_mov_b32 v188, 0
  v_mov_b32 v189, 0
  v_mov_b32 v190, 0
  v_mov_b32 v191, 0
  v_mov_b32 v192, 0
  v_mov_b32 v193, 0
  v_mov_b32 v194, 0
  v_mov_b32 v195, 0
  v_mov_b32 v196, 0
  v_mov_b32 v197, 0
  v_mov_b32 v198, 0
  v_mov_b32 v199, 0
  v_mov_b32 v200, 0
  v_mov_b32 v201, 0
  v_mov_b32 v202, 0
  v_mov_b32 v203, 0
  v_mov_b32 v204, 0
  v_mov_b32 v205, 0
  v_mov_b32 v206, 0
  v_mov_b32 v207, 0
  v_mov_b32 v208, 0
  v_mov_b32 v209, 0
  v_mov_b32 v210, 0
  v_mov_b32 v211, 0
  v_mov_b32 v212, 0
  v_mov_b32 v213, 0
  v_mov_b32 v214, 0
  v_mov_b32 v215, 0
  v_mov_b32 v216, 0
  v_mov_b32 v217, 0
  v_mov_b32 v218, 0
  v_mov_b32 v219, 0
  v_mov_b32 v220, 0
  v_mov_b32 v221, 0
  v_mov_b32 v222, 0
  v_mov_b32 v223, 0
  v_mov_b32 v224, 0
  v_mov_b32 v225, 0
  v_mov_b32 v226, 0
  v_mov_b32 v227, 0
  v_mov_b32 v228, 0
  v_mov_b32 v229, 0
  v_mov_b32 v230, 0
  v_mov_b32 v231, 0
  v_mov_b32 v232, 0
  v_mov_b32 v233, 0
  v_mov_b32 v234, 0
  v_mov_b32 v235, 0
  v_mov_b32 v236, 0
  v_mov_b32 v237, 0
  v_mov_b32 v238, 0
  v_mov_b32 v239, 0
  v_mov_b32 v240, 0
  v_mov_b32 v241, 0
  v_mov_b32 v242, 0
  v_mov_b32 v243, 0
  v_mov_b32 v244, 0
  v_mov_b32 v245, 0
  v_mov_b32 v246, 0
  v_mov_b32 v247, 0
  v_mov_b32 v248, 0
  v_mov_b32 v249, 0
  v_mov_b32 v250, 0
  v_mov_b32 v251, 0
  v_mov_b32 v252, 0
  v_mov_b32 v253, 0
  v_mov_b32 v254, 0
  v_mov_b32 v255, 0
  s_mul_i32 s20, s3, 57344
  s_add_u32 s20, s20, 3145728
  s_mov_b32 s25, 16
concat_heads__grouped_kv_mqa__linear_kernel_hedgehog__prompt_kernel_fb2:
  buffer_load_dwordx4 v[92:95], v120, s[8:11], s20 offen
  buffer_load_dwordx2 v[104:105], v121, s[8:11], s20 offen offset:3072
  buffer_load_dwordx4 v[96:99], v120, s[8:11], s20 offen offset:1024
  buffer_load_dwordx4 v[100:103], v120, s[8:11], s20 offen offset:2048
  s_waitcnt vmcnt(0)
  v_mfma_f32_32x32x16_bf16 v[52:67], v[92:95], v[4:7], 0
  v_mfma_f32_32x32x8_bf16 v[52:67], v[104:105], v[36:37], v[52:67]
  s_nop 15
  s_nop 7
  v_exp_f32 v52, v52
  v_exp_f32 v53, v53
  v_exp_f32 v54, v54
  v_exp_f32 v55, v55
  v_exp_f32 v56, v56
  v_exp_f32 v57, v57
  v_exp_f32 v58, v58
  v_exp_f32 v59, v59
  v_exp_f32 v60, v60
  v_exp_f32 v61, v61
  v_exp_f32 v62, v62
  v_exp_f32 v63, v63
  v_exp_f32 v64, v64
  v_exp_f32 v65, v65
  v_exp_f32 v66, v66
  v_exp_f32 v67, v67
  s_nop 1
  v_cvt_pk_bf16_f32 v84, v52, v53
  v_cvt_pk_bf16_f32 v85, v54, v55
  v_cvt_pk_bf16_f32 v86, v56, v57
  v_cvt_pk_bf16_f32 v87, v58, v59
  v_cvt_pk_bf16_f32 v88, v60, v61
  v_cvt_pk_bf16_f32 v89, v62, v63
  v_cvt_pk_bf16_f32 v90, v64, v65
  v_cvt_pk_bf16_f32 v91, v66, v67
  s_nop 1
  v_mfma_f32_32x32x16_bf16 v[128:143], v[96:99], v[84:87], v[128:143]
  v_mfma_f32_32x32x16_bf16 v[128:143], v[100:103], v[88:91], v[128:143]
  s_nop 7
  v_mfma_f32_32x32x16_bf16 v[52:67], v[92:95], v[8:11], 0
  v_mfma_f32_32x32x8_bf16 v[52:67], v[104:105], v[38:39], v[52:67]
  s_nop 15
  s_nop 7
  v_exp_f32 v52, v52
  v_exp_f32 v53, v53
  v_exp_f32 v54, v54
  v_exp_f32 v55, v55
  v_exp_f32 v56, v56
  v_exp_f32 v57, v57
  v_exp_f32 v58, v58
  v_exp_f32 v59, v59
  v_exp_f32 v60, v60
  v_exp_f32 v61, v61
  v_exp_f32 v62, v62
  v_exp_f32 v63, v63
  v_exp_f32 v64, v64
  v_exp_f32 v65, v65
  v_exp_f32 v66, v66
  v_exp_f32 v67, v67
  s_nop 1
  v_cvt_pk_bf16_f32 v84, v52, v53
  v_cvt_pk_bf16_f32 v85, v54, v55
  v_cvt_pk_bf16_f32 v86, v56, v57
  v_cvt_pk_bf16_f32 v87, v58, v59
  v_cvt_pk_bf16_f32 v88, v60, v61
  v_cvt_pk_bf16_f32 v89, v62, v63
  v_cvt_pk_bf16_f32 v90, v64, v65
  v_cvt_pk_bf16_f32 v91, v66, v67
  s_nop 1
  v_mfma_f32_32x32x16_bf16 v[144:159], v[96:99], v[84:87], v[144:159]
  v_mfma_f32_32x32x16_bf16 v[144:159], v[100:103], v[88:91], v[144:159]
  s_nop 7
  v_mfma_f32_32x32x16_bf16 v[52:67], v[92:95], v[12:15], 0
  v_mfma_f32_32x32x8_bf16 v[52:67], v[104:105], v[40:41], v[52:67]
  s_nop 15
  s_nop 7
  v_exp_f32 v52, v52
  v_exp_f32 v53, v53
  v_exp_f32 v54, v54
  v_exp_f32 v55, v55
  v_exp_f32 v56, v56
  v_exp_f32 v57, v57
  v_exp_f32 v58, v58
  v_exp_f32 v59, v59
  v_exp_f32 v60, v60
  v_exp_f32 v61, v61
  v_exp_f32 v62, v62
  v_exp_f32 v63, v63
  v_exp_f32 v64, v64
  v_exp_f32 v65, v65
  v_exp_f32 v66, v66
  v_exp_f32 v67, v67
  s_nop 1
  v_cvt_pk_bf16_f32 v84, v52, v53
  v_cvt_pk_bf16_f32 v85, v54, v55
  v_cvt_pk_bf16_f32 v86, v56, v57
  v_cvt_pk_bf16_f32 v87, v58, v59
  v_cvt_pk_bf16_f32 v88, v60, v61
  v_cvt_pk_bf16_f32 v89, v62, v63
  v_cvt_pk_bf16_f32 v90, v64, v65
  v_cvt_pk_bf16_f32 v91, v66, v67
  s_nop 1
  v_mfma_f32_32x32x16_bf16 v[160:175], v[96:99], v[84:87], v[160:175]
  v_mfma_f32_32x32x16_bf16 v[160:175], v[100:103], v[88:91], v[160:175]
  s_nop 7
  v_mfma_f32_32x32x16_bf16 v[52:67], v[92:95], v[16:19], 0
  v_mfma_f32_32x32x8_bf16 v[52:67], v[104:105], v[42:43], v[52:67]
  s_nop 15
  s_nop 7
  v_exp_f32 v52, v52
  v_exp_f32 v53, v53
  v_exp_f32 v54, v54
  v_exp_f32 v55, v55
  v_exp_f32 v56, v56
  v_exp_f32 v57, v57
  v_exp_f32 v58, v58
  v_exp_f32 v59, v59
  v_exp_f32 v60, v60
  v_exp_f32 v61, v61
  v_exp_f32 v62, v62
  v_exp_f32 v63, v63
  v_exp_f32 v64, v64
  v_exp_f32 v65, v65
  v_exp_f32 v66, v66
  v_exp_f32 v67, v67
  s_nop 1
  v_cvt_pk_bf16_f32 v84, v52, v53
  v_cvt_pk_bf16_f32 v85, v54, v55
  v_cvt_pk_bf16_f32 v86, v56, v57
  v_cvt_pk_bf16_f32 v87, v58, v59
  v_cvt_pk_bf16_f32 v88, v60, v61
  v_cvt_pk_bf16_f32 v89, v62, v63
  v_cvt_pk_bf16_f32 v90, v64, v65
  v_cvt_pk_bf16_f32 v91, v66, v67
  s_nop 1
  v_mfma_f32_32x32x16_bf16 v[176:191], v[96:99], v[84:87], v[176:191]
  v_mfma_f32_32x32x16_bf16 v[176:191], v[100:103], v[88:91], v[176:191]
  s_nop 7
  v_mfma_f32_32x32x16_bf16 v[52:67], v[92:95], v[20:23], 0
  v_mfma_f32_32x32x8_bf16 v[52:67], v[104:105], v[44:45], v[52:67]
  s_nop 15
  s_nop 7
  v_exp_f32 v52, v52
  v_exp_f32 v53, v53
  v_exp_f32 v54, v54
  v_exp_f32 v55, v55
  v_exp_f32 v56, v56
  v_exp_f32 v57, v57
  v_exp_f32 v58, v58
  v_exp_f32 v59, v59
  v_exp_f32 v60, v60
  v_exp_f32 v61, v61
  v_exp_f32 v62, v62
  v_exp_f32 v63, v63
  v_exp_f32 v64, v64
  v_exp_f32 v65, v65
  v_exp_f32 v66, v66
  v_exp_f32 v67, v67
  s_nop 1
  v_cvt_pk_bf16_f32 v84, v52, v53
  v_cvt_pk_bf16_f32 v85, v54, v55
  v_cvt_pk_bf16_f32 v86, v56, v57
  v_cvt_pk_bf16_f32 v87, v58, v59
  v_cvt_pk_bf16_f32 v88, v60, v61
  v_cvt_pk_bf16_f32 v89, v62, v63
  v_cvt_pk_bf16_f32 v90, v64, v65
  v_cvt_pk_bf16_f32 v91, v66, v67
  s_nop 1
  v_mfma_f32_32x32x16_bf16 v[192:207], v[96:99], v[84:87], v[192:207]
  v_mfma_f32_32x32x16_bf16 v[192:207], v[100:103], v[88:91], v[192:207]
  s_nop 7
  v_mfma_f32_32x32x16_bf16 v[52:67], v[92:95], v[24:27], 0
  v_mfma_f32_32x32x8_bf16 v[52:67], v[104:105], v[46:47], v[52:67]
  s_nop 15
  s_nop 7
  v_exp_f32 v52, v52
  v_exp_f32 v53, v53
  v_exp_f32 v54, v54
  v_exp_f32 v55, v55
  v_exp_f32 v56, v56
  v_exp_f32 v57, v57
  v_exp_f32 v58, v58
  v_exp_f32 v59, v59
  v_exp_f32 v60, v60
  v_exp_f32 v61, v61
  v_exp_f32 v62, v62
  v_exp_f32 v63, v63
  v_exp_f32 v64, v64
  v_exp_f32 v65, v65
  v_exp_f32 v66, v66
  v_exp_f32 v67, v67
  s_nop 1
  v_cvt_pk_bf16_f32 v84, v52, v53
  v_cvt_pk_bf16_f32 v85, v54, v55
  v_cvt_pk_bf16_f32 v86, v56, v57
  v_cvt_pk_bf16_f32 v87, v58, v59
  v_cvt_pk_bf16_f32 v88, v60, v61
  v_cvt_pk_bf16_f32 v89, v62, v63
  v_cvt_pk_bf16_f32 v90, v64, v65
  v_cvt_pk_bf16_f32 v91, v66, v67
  s_nop 1
  v_mfma_f32_32x32x16_bf16 v[208:223], v[96:99], v[84:87], v[208:223]
  v_mfma_f32_32x32x16_bf16 v[208:223], v[100:103], v[88:91], v[208:223]
  s_nop 7
  v_mfma_f32_32x32x16_bf16 v[52:67], v[92:95], v[28:31], 0
  v_mfma_f32_32x32x8_bf16 v[52:67], v[104:105], v[48:49], v[52:67]
  s_nop 15
  s_nop 7
  v_exp_f32 v52, v52
  v_exp_f32 v53, v53
  v_exp_f32 v54, v54
  v_exp_f32 v55, v55
  v_exp_f32 v56, v56
  v_exp_f32 v57, v57
  v_exp_f32 v58, v58
  v_exp_f32 v59, v59
  v_exp_f32 v60, v60
  v_exp_f32 v61, v61
  v_exp_f32 v62, v62
  v_exp_f32 v63, v63
  v_exp_f32 v64, v64
  v_exp_f32 v65, v65
  v_exp_f32 v66, v66
  v_exp_f32 v67, v67
  s_nop 1
  v_cvt_pk_bf16_f32 v84, v52, v53
  v_cvt_pk_bf16_f32 v85, v54, v55
  v_cvt_pk_bf16_f32 v86, v56, v57
  v_cvt_pk_bf16_f32 v87, v58, v59
  v_cvt_pk_bf16_f32 v88, v60, v61
  v_cvt_pk_bf16_f32 v89, v62, v63
  v_cvt_pk_bf16_f32 v90, v64, v65
  v_cvt_pk_bf16_f32 v91, v66, v67
  s_nop 1
  v_mfma_f32_32x32x16_bf16 v[224:239], v[96:99], v[84:87], v[224:239]
  v_mfma_f32_32x32x16_bf16 v[224:239], v[100:103], v[88:91], v[224:239]
  s_nop 7
  v_mfma_f32_32x32x16_bf16 v[52:67], v[92:95], v[32:35], 0
  v_mfma_f32_32x32x8_bf16 v[52:67], v[104:105], v[50:51], v[52:67]
  s_nop 15
  s_nop 7
  v_exp_f32 v52, v52
  v_exp_f32 v53, v53
  v_exp_f32 v54, v54
  v_exp_f32 v55, v55
  v_exp_f32 v56, v56
  v_exp_f32 v57, v57
  v_exp_f32 v58, v58
  v_exp_f32 v59, v59
  v_exp_f32 v60, v60
  v_exp_f32 v61, v61
  v_exp_f32 v62, v62
  v_exp_f32 v63, v63
  v_exp_f32 v64, v64
  v_exp_f32 v65, v65
  v_exp_f32 v66, v66
  v_exp_f32 v67, v67
  s_nop 1
  v_cvt_pk_bf16_f32 v84, v52, v53
  v_cvt_pk_bf16_f32 v85, v54, v55
  v_cvt_pk_bf16_f32 v86, v56, v57
  v_cvt_pk_bf16_f32 v87, v58, v59
  v_cvt_pk_bf16_f32 v88, v60, v61
  v_cvt_pk_bf16_f32 v89, v62, v63
  v_cvt_pk_bf16_f32 v90, v64, v65
  v_cvt_pk_bf16_f32 v91, v66, v67
  s_nop 1
  v_mfma_f32_32x32x16_bf16 v[240:255], v[96:99], v[84:87], v[240:255]
  v_mfma_f32_32x32x16_bf16 v[240:255], v[100:103], v[88:91], v[240:255]
  s_nop 7
  s_add_u32 s20, s20, 3584
  s_sub_u32 s25, s25, 1
  s_cmp_lg_u32 s25, 0
  s_cbranch_scc1 concat_heads__grouped_kv_mqa__linear_kernel_hedgehog__prompt_kernel_fb2
  s_branch concat_heads__grouped_kv_mqa__linear_kernel_hedgehog__prompt_kernel_epi
concat_heads__grouped_kv_mqa__linear_kernel_hedgehog__prompt_kernel_end:
  s_endpgm

.section .rodata,"a"
.p2align 6
.amdhsa_kernel concat_heads__grouped_kv_mqa__linear_kernel_hedgehog__prompt_kernel
  .amdhsa_next_free_vgpr 256
  .amdhsa_next_free_sgpr 102
  .amdhsa_accum_offset 256
  .amdhsa_group_segment_fixed_size 0
  .amdhsa_kernarg_size 96
  .amdhsa_user_sgpr_count 2
  .amdhsa_user_sgpr_kernarg_segment_ptr 1
  .amdhsa_system_sgpr_workgroup_id_x 1
  .amdhsa_float_denorm_mode_32 3
.end_amdhsa_kernel
```
